```python
import torch

def _softmax(x, axis=-1):
    return torch.softmax(x, dim=axis)

def _gelu(x):
    return torch.nn.functional.gelu(x, approximate='tanh')

def _silu(x):
    return torch.nn.functional.silu(x)

def _sigmoid(x):
    return torch.sigmoid(x)

def _layernorm(x, axis=-1, eps=1e-05):
    m = x.mean(dim=axis, keepdim=True)
    v = x.var(dim=axis, keepdim=True, unbiased=False)
    return (x - m) / torch.sqrt(v + eps)

def _scatter_add(tgt, idx, src, axis=0):
    return tgt.clone().index_add_(axis, idx, src)

def _segment_sum(src, seg, n):
    out = torch.zeros((n,) + src.shape[1:], dtype=src.dtype)
    return out.index_add_(0, seg, src)

def _pad(x, pw):
    flat = tuple((v for pair in reversed(pw) for v in pair))
    return torch.nn.functional.pad(x, flat)
kernel_name = 'adaLN_cond__sliding_block_cached__glu_gated_glu__decode'

def setup_inputs():

    _w = lambda a: (lambda t: t.to(torch.bfloat16) if t.is_floating_point() else t)(torch.as_tensor(a))

    def _A_setup():
        B, Sq, D = (4, 1, 512)
        Hq, Hkv, Sk, Dh = (32, 8, 4096, 128)
        assert Hq % Hkv == 0, (Hq, Hkv)
        return {'x': _w((lambda *s: torch.randn(*s, dtype=torch.bfloat16) * 0.05)(B, Sq, D)), 'k_cache': _w((lambda *s: torch.randn(*s, dtype=torch.bfloat16) * 3.2)(B, Hkv, Sk, Dh)), 'v_cache': _w((lambda *s: torch.randn(*s, dtype=torch.bfloat16) * 0.4)(B, Hkv, Sk, Dh)), 'wq': _w((lambda *s: torch.randn(*s, dtype=torch.bfloat16) * 3.2)(D, Hq * Dh) * D ** (-0.5)), 'wo': _w((lambda *s: torch.randn(*s, dtype=torch.bfloat16) * 0.4)(Hq * Dh, D) * (Hq * Dh) ** (-0.5))}
    _A_in = _A_setup()

    def _B_setup():
        B, S, D, F = (4, 1, 512, 1792)
        return {'x': _w((lambda *s: torch.randn(*s, dtype=torch.bfloat16) * 0.05)(B, S, D)), 'w_gate': _w((lambda *s: torch.randn(*s, dtype=torch.bfloat16) * 0.05)(D, F)), 'w_up': _w((lambda *s: torch.randn(*s, dtype=torch.bfloat16) * 0.05)(D, F)), 'w_down': _w((lambda *s: torch.randn(*s, dtype=torch.bfloat16) * 0.05)(F, D))}
    _B_in = _B_setup()
    return {'A_x': _A_in['x'], 'A_k_cache': _A_in['k_cache'], 'A_v_cache': _A_in['v_cache'], 'A_wq': _A_in['wq'], 'A_wo': _A_in['wo'], 'B_x': _B_in['x'], 'B_w_gate': _B_in['w_gate'], 'B_w_up': _B_in['w_up'], 'B_w_down': _B_in['w_down'], 'c': _w((lambda *s: torch.randn(*s, dtype=torch.bfloat16) * 0.1)(4, 512) * 8.0), 'w_mod': _w((lambda *s: torch.randn(*s, dtype=torch.bfloat16) * 0.1)(512, 6 * 512) * 512 ** (-0.5) * 8.0)}

def reference(A_x, A_k_cache, A_v_cache, A_wq, A_wo, B_x, B_w_gate, B_w_up, B_w_down, c, w_mod):

    def _A_ref(x, k_cache, v_cache, wq, wo):
        B, Sq, D = x.shape
        Hq, Dh = (32, 128)
        Hkv, Sk = (k_cache.shape[1], k_cache.shape[2])
        W = min(4096, max(256, Sk // 4))
        rep = Hq // Hkv
        q = (lambda x, *d: x.permute(*d))((x @ wq).reshape(B, Sq, Hq, Dh), 0, 2, 1, 3)
        k = (lambda x, n, axis: torch.repeat_interleave(x, n, dim=axis))(k_cache[:, :, Sk - W:, :], rep, axis=1)
        v = (lambda x, n, axis: torch.repeat_interleave(x, n, dim=axis))(v_cache[:, :, Sk - W:, :], rep, axis=1)
        scores = torch.einsum('bhqd,bhkd->bhqk', q, k) * Dh ** (-0.5)
        p = _softmax(scores, axis=-1)
        o = torch.einsum('bhqk,bhkd->bhqd', p, v)
        return (lambda x, *d: x.permute(*d))(o, 0, 2, 1, 3).reshape(B, Sq, Hq * Dh) @ wo

    def _B_ref(x, w_gate, w_up, w_down):
        g = torch.einsum('bsd,df->bsf', x, w_gate)
        u = torch.einsum('bsd,df->bsf', x, w_up)
        h = _sigmoid(g) * u
        return torch.einsum('bsf,fd->bsd', h, w_down)
    x = A_x
    mod = (_silu(c) @ w_mod).reshape(c.shape[0], 6, 1, -1)
    sa, ca, ga, sb, cb, gb = (mod[:, 0].clone(), mod[:, 1].clone(), mod[:, 2].clone(), mod[:, 3].clone(), mod[:, 4].clone(), mod[:, 5].clone())
    h = _layernorm(x, axis=-1) * (1 + ca) + sa
    x = x + ga * _A_ref(h, A_k_cache, A_v_cache, A_wq, A_wo)
    h = _layernorm(x, axis=-1) * (1 + cb) + sb
    x = x + gb * _B_ref(h, B_w_gate, B_w_up, B_w_down)
    return x
```

```asm
; @launch grid=(256,1,1) block=(256,1,1) lds=139264
.amdgcn_target "amdgcn-amd-amdhsa--gfx950"
.text
.globl adaLN_cond__sliding_block_cached__glu_gated_glu__decode_kernel
.p2align 8
.type adaLN_cond__sliding_block_cached__glu_gated_glu__decode_kernel,@function
adaLN_cond__sliding_block_cached__glu_gated_glu__decode_kernel:
  s_cmp_ge_u32 s2, 256
  s_cbranch_scc1 L_end
  s_load_dwordx16 s[16:31], s[0:1], 0
  s_load_dwordx8 s[32:39], s[0:1], 64
  s_load_dwordx4 s[40:43], s[0:1], 96
  s_memrealtime s[68:69]
  v_lshrrev_b32 v6, 6, v0
  v_and_b32 v1, 63, v0
  s_and_b32 s4, s2, 7
  s_lshr_b32 s5, s2, 3
  s_getpc_b64 s[70:71]
L_pf0:
  s_mov_b32 s72, L_roleM-L_pf0
  s_cmp_lt_u32 s5, 28
  s_cselect_b32 s72, L_roleJ-L_pf0, s72
  s_mov_b32 s73, L_roleQ-L_pf0
  s_cmp_lt_u32 s5, 24
  s_cselect_b32 s72, s73, s72
  s_mov_b32 s73, L_roleA-L_pf0
  s_cmp_lt_u32 s5, 16
  s_cselect_b32 s72, s73, s72
  s_add_u32 s70, s70, s72
  s_addc_u32 s71, s71, 0
  v_lshlrev_b32 v3, 5, v1
  global_load_dword v4, v3, s[70:71]
  v_readfirstlane_b32 s3, v6
  v_mov_b32 v6, 0
  s_mov_b32 s56, 0x0c0c0400
  s_mov_b32 s57, 117835008
  s_mov_b32 s58, 117835009
  s_mov_b32 s59, 117835010
  s_mov_b32 s60, 117835011
  s_mov_b32 s64, 0x000f000f
  s_mov_b32 s65, 0x000f000f
  s_waitcnt lgkmcnt(0)
  s_mov_b32 s67, s68
  s_mov_b32 s8, s42
  s_mov_b32 s9, s43
  s_mov_b32 s10, 4194304
  s_mov_b32 s11, 0x20000
  s_mov_b32 s52, s40
  s_mov_b32 s53, s41
  s_mov_b32 s54, 256
  s_mov_b32 s55, 0x20000
  s_cmp_lt_u32 s5, 16
  s_cbranch_scc1 L_roleA
  s_cmp_lt_u32 s5, 24
  s_cbranch_scc1 L_roleQ
  s_cmp_lt_u32 s5, 28
  s_cbranch_scc1 L_roleJ
  s_branch L_roleM
L_roleJ:
  s_mov_b32 s12, s36
  s_mov_b32 s13, s37
  s_mov_b32 s14, 3145728
  s_mov_b32 s15, 0x20000
  s_mov_b32 s44, s34
  s_mov_b32 s45, s35
  s_mov_b32 s46, 4096
  s_mov_b32 s47, 0x20000
  s_lshl_b32 s7, s3, 10
  v_lshl_add_u32 v8, v1, 3, s7
  buffer_load_dwordx2 v[32:33], v8, s[44:47], 0 offen
  buffer_load_dwordx2 v[34:35], v8, s[44:47], 0 offen offset:512
  v_lshrrev_b32 v12, 3, v1
  s_mov_b32 s7, 6144
  v_mul_lo_u32 v12, v12, s7
  v_bfe_u32 v8, v1, 1, 2
  v_bfe_u32 v9, v1, 4, 2
  v_xor_b32 v8, v8, v9
  v_lshl_add_u32 v12, v8, 5, v12
  v_and_b32 v8, 1, v1
  v_lshl_add_u32 v12, v8, 4, v12
  s_sub_u32 s7, s5, 24
  s_and_b32 s70, s7, 1
  s_lshr_b32 s73, s7, 1
  s_lshl_b32 s7, s4, 1
  s_add_u32 s73, s73, s7
  s_lshl_b32 s69, s70, 10
  s_lshl_b32 s7, s73, 7
  s_add_u32 s69, s69, s7
  s_cmp_ge_u32 s4, 4
  s_cbranch_scc1 L_help_1
  s_mul_i32 s68, s3, 196608
  s_add_u32 s68, s68, s69
  s_lshl_b32 s7, s3, 12
  s_add_u32 s7, s7, 0
  s_mov_b32 m0, s7
  s_nop 0
  buffer_load_dwordx4 v12, s[12:15], s68 offen nt lds
  s_add_u32 m0, m0, 1024
  s_add_u32 s68, s68, 49152
  buffer_load_dwordx4 v12, s[12:15], s68 offen nt lds
  s_add_u32 m0, m0, 1024
  s_add_u32 s68, s68, 49152
  buffer_load_dwordx4 v12, s[12:15], s68 offen nt lds
  s_add_u32 m0, m0, 1024
  s_add_u32 s68, s68, 49152
  buffer_load_dwordx4 v12, s[12:15], s68 offen nt lds
  s_add_u32 m0, m0, 13312
  s_add_u32 s68, s68, 638976
  buffer_load_dwordx4 v12, s[12:15], s68 offen nt lds
  s_add_u32 m0, m0, 1024
  s_add_u32 s68, s68, 49152
  buffer_load_dwordx4 v12, s[12:15], s68 offen nt lds
  s_add_u32 m0, m0, 1024
  s_add_u32 s68, s68, 49152
  buffer_load_dwordx4 v12, s[12:15], s68 offen nt lds
  s_add_u32 m0, m0, 1024
  s_add_u32 s68, s68, 49152
  buffer_load_dwordx4 v12, s[12:15], s68 offen nt lds
  s_add_u32 m0, m0, 13312
  s_add_u32 s68, s68, 638976
  buffer_load_dwordx4 v12, s[12:15], s68 offen nt lds
  s_add_u32 m0, m0, 1024
  s_add_u32 s68, s68, 49152
  buffer_load_dwordx4 v12, s[12:15], s68 offen nt lds
  s_add_u32 m0, m0, 1024
  s_add_u32 s68, s68, 49152
  buffer_load_dwordx4 v12, s[12:15], s68 offen nt lds
  s_add_u32 m0, m0, 1024
  s_add_u32 s68, s68, 49152
  buffer_load_dwordx4 v12, s[12:15], s68 offen nt lds
  s_add_u32 m0, m0, 13312
  s_add_u32 s68, s68, 638976
  buffer_load_dwordx4 v12, s[12:15], s68 offen nt lds
  s_add_u32 m0, m0, 1024
  s_add_u32 s68, s68, 49152
  buffer_load_dwordx4 v12, s[12:15], s68 offen nt lds
  s_add_u32 m0, m0, 1024
  s_add_u32 s68, s68, 49152
  buffer_load_dwordx4 v12, s[12:15], s68 offen nt lds
  s_add_u32 m0, m0, 1024
  s_add_u32 s68, s68, 49152
  buffer_load_dwordx4 v12, s[12:15], s68 offen nt lds
  s_mov_b32 s71, 0
  s_branch L_helpd_2
L_help_1:
  s_cmp_ge_u32 s5, 27
  s_cbranch_scc1 L_nq_3
  s_sub_u32 s73, s5, 25
  s_mov_b32 s48, s22
  s_mov_b32 s49, s23
  s_mov_b32 s50, 4194304
  s_mov_b32 s51, 0x20000
  v_lshrrev_b32 v14, 3, v1
  s_mov_b32 s7, 8192
  v_mul_lo_u32 v14, v14, s7
  v_bfe_u32 v8, v1, 1, 2
  v_bfe_u32 v9, v1, 4, 2
  v_xor_b32 v8, v8, v9
  v_lshl_add_u32 v14, v8, 5, v14
  v_and_b32 v8, 1, v1
  v_lshl_add_u32 v14, v8, 4, v14
  s_lshl_b32 s69, s4, 10
  s_add_u32 s69, s69, 384
  s_mul_i32 s7, s73, 1048576
  s_add_u32 s69, s69, s7
  s_mul_i32 s68, s3, 262144
  s_add_u32 s68, s68, s69
  s_add_u32 s68, s68, 2097152
  s_lshl_b32 s7, s3, 12
  s_add_u32 s7, s7, 98304
  s_mov_b32 m0, s7
  s_nop 0
  buffer_load_dwordx4 v14, s[48:51], s68 offen  lds
  s_add_u32 m0, m0, 1024
  s_add_u32 s68, s68, 65536
  buffer_load_dwordx4 v14, s[48:51], s68 offen  lds
  s_add_u32 m0, m0, 1024
  s_add_u32 s68, s68, 65536
  buffer_load_dwordx4 v14, s[48:51], s68 offen  lds
  s_add_u32 m0, m0, 1024
  s_add_u32 s68, s68, 65536
  buffer_load_dwordx4 v14, s[48:51], s68 offen  lds
L_nq_3:
  s_mov_b32 s71, 1
  s_waitcnt vmcnt(0)
L_helpd_2:
  buffer_load_dword v2, v6, s[52:55], 0 offen sc1
  v_lshrrev_b32 v10, 3, v1
  v_lshlrev_b32 v10, 8, v10
  v_and_b32 v8, 3, v1
  v_lshl_add_u32 v10, v8, 4, v10
  v_bfe_u32 v8, v1, 2, 1
  v_lshl_add_u32 v10, v8, 3, v10
  s_lshl_b32 s7, s3, 6
  s_add_u32 s7, s7, 131072
  v_add_u32 v10, s7, v10
  v_and_b32 v11, 3, v1
  v_lshlrev_b32 v11, 6, v11
  v_lshrrev_b32 v8, 4, v1
  v_lshl_add_u32 v11, v8, 4, v11
  v_add_u32 v11, 131072, v11
  v_lshrrev_b32 v13, 2, v1
  v_lshlrev_b32 v13, 7, v13
  v_bfe_u32 v8, v1, 3, 2
  v_xor_b32 v8, s3, v8
  v_lshl_add_u32 v13, v8, 5, v13
  v_and_b32 v8, 3, v1
  v_lshl_add_u32 v13, v8, 3, v13
  s_waitcnt vmcnt(17)
  v_lshlrev_b32 v16, 16, v32
  v_and_b32 v17, 0xffff0000, v32
  v_lshlrev_b32 v18, 16, v33
  v_and_b32 v19, 0xffff0000, v33
  v_lshlrev_b32 v20, 16, v34
  v_and_b32 v21, 0xffff0000, v34
  v_lshlrev_b32 v22, 16, v35
  v_and_b32 v23, 0xffff0000, v35
  v_mul_f32 v24, 0xbfb8aa3b, v16
  v_mul_f32 v25, 0xbfb8aa3b, v17
  v_mul_f32 v26, 0xbfb8aa3b, v18
  v_mul_f32 v27, 0xbfb8aa3b, v19
  v_mul_f32 v28, 0xbfb8aa3b, v20
  v_mul_f32 v29, 0xbfb8aa3b, v21
  v_mul_f32 v30, 0xbfb8aa3b, v22
  v_mul_f32 v31, 0xbfb8aa3b, v23
  v_exp_f32 v24, v24
  v_exp_f32 v25, v25
  v_exp_f32 v26, v26
  v_exp_f32 v27, v27
  v_exp_f32 v28, v28
  v_exp_f32 v29, v29
  v_exp_f32 v30, v30
  v_exp_f32 v31, v31
  v_add_f32 v24, 1.0, v24
  v_add_f32 v25, 1.0, v25
  v_add_f32 v26, 1.0, v26
  v_add_f32 v27, 1.0, v27
  v_add_f32 v28, 1.0, v28
  v_add_f32 v29, 1.0, v29
  v_add_f32 v30, 1.0, v30
  v_add_f32 v31, 1.0, v31
  v_rcp_f32 v24, v24
  v_rcp_f32 v25, v25
  v_rcp_f32 v26, v26
  v_rcp_f32 v27, v27
  v_rcp_f32 v28, v28
  v_rcp_f32 v29, v29
  v_rcp_f32 v30, v30
  v_rcp_f32 v31, v31
  v_mul_f32 v16, v16, v24
  v_mul_f32 v17, v17, v25
  v_mul_f32 v18, v18, v26
  v_mul_f32 v19, v19, v27
  v_mul_f32 v20, v20, v28
  v_mul_f32 v21, v21, v29
  v_mul_f32 v22, v22, v30
  v_mul_f32 v23, v23, v31
  v_cvt_pk_bf16_f32 v36, v16, v17
  v_cvt_pk_bf16_f32 v37, v18, v19
  v_cvt_pk_bf16_f32 v38, v20, v21
  v_cvt_pk_bf16_f32 v39, v22, v23
  ds_write_b64 v10, v[36:37]
  ds_write_b64 v10, v[38:39] offset:2048
  s_waitcnt lgkmcnt(0)
  s_barrier
  ds_read_b128 v[44:47], v11 offset:0
  ds_read_b128 v[48:51], v11 offset:256
  ds_read_b128 v[52:55], v11 offset:512
  ds_read_b128 v[56:59], v11 offset:768
  ds_read_b128 v[60:63], v11 offset:1024
  ds_read_b128 v[64:67], v11 offset:1280
  ds_read_b128 v[68:71], v11 offset:1536
  ds_read_b128 v[72:75], v11 offset:1792
  ds_read_b128 v[76:79], v11 offset:2048
  ds_read_b128 v[80:83], v11 offset:2304
  ds_read_b128 v[84:87], v11 offset:2560
  ds_read_b128 v[88:91], v11 offset:2816
  s_waitcnt lgkmcnt(4)
  ds_read_b128 v[92:95], v11 offset:3072
  ds_read_b128 v[96:99], v11 offset:3328
  ds_read_b128 v[100:103], v11 offset:3584
  ds_read_b128 v[104:107], v11 offset:3840
  s_waitcnt lgkmcnt(0)
  v_and_b32 v15, 15, v1
  v_lshlrev_b32 v15, 4, v15
  v_lshrrev_b32 v8, 4, v1
  v_lshl_add_u32 v15, v8, 6, v15
L_job_4:
  s_mov_b32 s72, 0
  s_cmp_eq_u32 s71, 0
  s_cbranch_scc1 L_jfirst_5
  s_waitcnt vmcnt(0)
  s_mov_b32 s66, 0
L_non_6:
  v_readfirstlane_b32 s6, v2
  s_cmp_lg_u32 s6, 0
  s_cbranch_scc1 L_nok_7
  buffer_load_dword v2, v6, s[52:55], 0 offen sc1
  s_add_u32 s66, s66, 1
  s_cmp_lt_u32 s66, 200000
  s_cbranch_scc0 L_exit
  s_waitcnt vmcnt(0)
  s_branch L_non_6
L_nok_7:
  v_mov_b32 v2, s6
  s_and_b32 s98, s6, 0xff
  s_bfe_u32 s99, s6, 524296
  s_bfe_u32 s100, s6, 524304
  s_bfe_u32 s101, s6, 524312
  s_lshl_b32 s76, s4, 10
  s_add_u32 s76, s76, 0
  s_mov_b32 s66, 0
L_poll_8:
  buffer_load_dwordx4 v[36:39], v6, s[8:11], s76 offen sc1
  s_waitcnt vmcnt(0)
  v_xor_b32 v36, s98, v36
  v_xor_b32 v37, s99, v37
  v_xor_b32 v38, s100, v38
  v_xor_b32 v39, s101, v39
  v_or3_b32 v8, v36, v37, v38
  v_or_b32 v8, v8, v39
  v_cmp_ne_u32_sdwa vcc, v8, v6 src0_sel:BYTE_0 src1_sel:DWORD
  s_cbranch_vccz L_ok_9
  s_add_u32 s66, s66, 1
  s_cmp_lt_u32 s66, 200000
  s_cbranch_scc1 L_poll_8
  s_branch L_exit
L_ok_9:
  s_sub_u32 s70, s5, 22
  s_mov_b32 s72, 65536
  s_mov_b32 s73, s4
  s_lshl_b32 s69, s70, 10
  s_lshl_b32 s7, s4, 7
  s_add_u32 s69, s69, s7
  s_mul_i32 s68, s3, 196608
  s_add_u32 s68, s68, s69
  s_lshl_b32 s7, s3, 12
  s_add_u32 s7, s7, 65536
  s_mov_b32 m0, s7
  s_nop 0
  buffer_load_dwordx4 v12, s[12:15], s68 offen nt lds
  s_add_u32 m0, m0, 1024
  s_add_u32 s68, s68, 49152
  buffer_load_dwordx4 v12, s[12:15], s68 offen nt lds
  s_add_u32 m0, m0, 1024
  s_add_u32 s68, s68, 49152
  buffer_load_dwordx4 v12, s[12:15], s68 offen nt lds
  s_add_u32 m0, m0, 1024
  s_add_u32 s68, s68, 49152
  buffer_load_dwordx4 v12, s[12:15], s68 offen nt lds
  s_add_u32 m0, m0, 13312
  s_add_u32 s68, s68, 638976
  buffer_load_dwordx4 v12, s[12:15], s68 offen nt lds
  s_add_u32 m0, m0, 1024
  s_add_u32 s68, s68, 49152
  buffer_load_dwordx4 v12, s[12:15], s68 offen nt lds
  s_add_u32 m0, m0, 1024
  s_add_u32 s68, s68, 49152
  buffer_load_dwordx4 v12, s[12:15], s68 offen nt lds
  s_add_u32 m0, m0, 1024
  s_add_u32 s68, s68, 49152
  buffer_load_dwordx4 v12, s[12:15], s68 offen nt lds
  s_add_u32 m0, m0, 13312
  s_add_u32 s68, s68, 638976
  buffer_load_dwordx4 v12, s[12:15], s68 offen nt lds
  s_add_u32 m0, m0, 1024
  s_add_u32 s68, s68, 49152
  buffer_load_dwordx4 v12, s[12:15], s68 offen nt lds
  s_add_u32 m0, m0, 1024
  s_add_u32 s68, s68, 49152
  buffer_load_dwordx4 v12, s[12:15], s68 offen nt lds
  s_add_u32 m0, m0, 1024
  s_add_u32 s68, s68, 49152
  buffer_load_dwordx4 v12, s[12:15], s68 offen nt lds
  s_add_u32 m0, m0, 13312
  s_add_u32 s68, s68, 638976
  buffer_load_dwordx4 v12, s[12:15], s68 offen nt lds
  s_add_u32 m0, m0, 1024
  s_add_u32 s68, s68, 49152
  buffer_load_dwordx4 v12, s[12:15], s68 offen nt lds
  s_add_u32 m0, m0, 1024
  s_add_u32 s68, s68, 49152
  buffer_load_dwordx4 v12, s[12:15], s68 offen nt lds
  s_add_u32 m0, m0, 1024
  s_add_u32 s68, s68, 49152
  buffer_load_dwordx4 v12, s[12:15], s68 offen nt lds
  buffer_load_dword v2, v6, s[52:55], 0 offen sc1
L_jfirst_5:
  v_add_u32 v14, s72, v13
  s_waitcnt vmcnt(13)
  s_barrier
  ds_read_b64_tr_b16 v[108:109], v14 offset:0
  ds_read_b64_tr_b16 v[110:111], v14 offset:2048
  ds_read_b64_tr_b16 v[112:113], v14 offset:4096
  ds_read_b64_tr_b16 v[114:115], v14 offset:6144
  ds_read_b64_tr_b16 v[116:117], v14 offset:8192
  ds_read_b64_tr_b16 v[118:119], v14 offset:10240
  ds_read_b64_tr_b16 v[120:121], v14 offset:12288
  ds_read_b64_tr_b16 v[122:123], v14 offset:14336
  s_waitcnt lgkmcnt(6)
  v_mfma_f32_16x16x32_bf16 v[40:43], v[108:111], v[44:47], 0
  s_waitcnt lgkmcnt(4)
  v_mfma_f32_16x16x32_bf16 v[40:43], v[112:115], v[48:51], v[40:43]
  s_waitcnt lgkmcnt(2)
  v_mfma_f32_16x16x32_bf16 v[40:43], v[116:119], v[52:55], v[40:43]
  s_waitcnt lgkmcnt(0)
  v_mfma_f32_16x16x32_bf16 v[40:43], v[120:123], v[56:59], v[40:43]
  s_waitcnt vmcnt(9)
  s_barrier
  ds_read_b64_tr_b16 v[108:109], v14 offset:16384
  ds_read_b64_tr_b16 v[110:111], v14 offset:18432
  ds_read_b64_tr_b16 v[112:113], v14 offset:20480
  ds_read_b64_tr_b16 v[114:115], v14 offset:22528
  ds_read_b64_tr_b16 v[116:117], v14 offset:24576
  ds_read_b64_tr_b16 v[118:119], v14 offset:26624
  ds_read_b64_tr_b16 v[120:121], v14 offset:28672
  ds_read_b64_tr_b16 v[122:123], v14 offset:30720
  s_waitcnt lgkmcnt(6)
  v_mfma_f32_16x16x32_bf16 v[40:43], v[108:111], v[60:63], v[40:43]
  s_waitcnt lgkmcnt(4)
  v_mfma_f32_16x16x32_bf16 v[40:43], v[112:115], v[64:67], v[40:43]
  s_waitcnt lgkmcnt(2)
  v_mfma_f32_16x16x32_bf16 v[40:43], v[116:119], v[68:71], v[40:43]
  s_waitcnt lgkmcnt(0)
  v_mfma_f32_16x16x32_bf16 v[40:43], v[120:123], v[72:75], v[40:43]
  s_waitcnt vmcnt(5)
  s_barrier
  ds_read_b64_tr_b16 v[108:109], v14 offset:32768
  ds_read_b64_tr_b16 v[110:111], v14 offset:34816
  ds_read_b64_tr_b16 v[112:113], v14 offset:36864
  ds_read_b64_tr_b16 v[114:115], v14 offset:38912
  ds_read_b64_tr_b16 v[116:117], v14 offset:40960
  ds_read_b64_tr_b16 v[118:119], v14 offset:43008
  ds_read_b64_tr_b16 v[120:121], v14 offset:45056
  ds_read_b64_tr_b16 v[122:123], v14 offset:47104
  s_waitcnt lgkmcnt(6)
  v_mfma_f32_16x16x32_bf16 v[40:43], v[108:111], v[76:79], v[40:43]
  s_waitcnt lgkmcnt(4)
  v_mfma_f32_16x16x32_bf16 v[40:43], v[112:115], v[80:83], v[40:43]
  s_waitcnt lgkmcnt(2)
  v_mfma_f32_16x16x32_bf16 v[40:43], v[116:119], v[84:87], v[40:43]
  s_waitcnt lgkmcnt(0)
  v_mfma_f32_16x16x32_bf16 v[40:43], v[120:123], v[88:91], v[40:43]
  s_waitcnt vmcnt(1)
  s_barrier
  ds_read_b64_tr_b16 v[108:109], v14 offset:49152
  ds_read_b64_tr_b16 v[110:111], v14 offset:51200
  ds_read_b64_tr_b16 v[112:113], v14 offset:53248
  ds_read_b64_tr_b16 v[114:115], v14 offset:55296
  ds_read_b64_tr_b16 v[116:117], v14 offset:57344
  ds_read_b64_tr_b16 v[118:119], v14 offset:59392
  ds_read_b64_tr_b16 v[120:121], v14 offset:61440
  ds_read_b64_tr_b16 v[122:123], v14 offset:63488
  s_waitcnt lgkmcnt(6)
  v_mfma_f32_16x16x32_bf16 v[40:43], v[108:111], v[92:95], v[40:43]
  s_waitcnt lgkmcnt(4)
  v_mfma_f32_16x16x32_bf16 v[40:43], v[112:115], v[96:99], v[40:43]
  s_waitcnt lgkmcnt(2)
  v_mfma_f32_16x16x32_bf16 v[40:43], v[116:119], v[100:103], v[40:43]
  s_waitcnt lgkmcnt(0)
  v_mfma_f32_16x16x32_bf16 v[40:43], v[120:123], v[104:107], v[40:43]
  s_waitcnt vmcnt(0)
  s_mov_b32 s66, 0
L_non_10:
  v_readfirstlane_b32 s6, v2
  s_cmp_lg_u32 s6, 0
  s_cbranch_scc1 L_nok_11
  buffer_load_dword v2, v6, s[52:55], 0 offen sc1
  s_add_u32 s66, s66, 1
  s_cmp_lt_u32 s66, 200000
  s_cbranch_scc0 L_exit
  s_waitcnt vmcnt(0)
  s_branch L_non_10
L_nok_11:
  v_mov_b32 v2, s6
  s_and_b32 s98, s6, 0xff
  s_bfe_u32 s99, s6, 524296
  s_bfe_u32 s100, s6, 524304
  s_bfe_u32 s101, s6, 524312
  s_lshl_b32 s69, s70, 13
  s_lshl_b32 s7, s73, 10
  s_add_u32 s69, s69, s7
  s_lshl_b32 s7, s3, 8
  s_add_u32 s69, s69, s7
  v_perm_b32 v36, v40, v2, s57
  v_perm_b32 v37, v41, v2, s58
  v_perm_b32 v38, v42, v2, s59
  v_perm_b32 v39, v43, v2, s60
  s_mov_b64 exec, s[64:65]
  buffer_store_dwordx4 v[36:39], v15, s[8:11], s69 offen sc1
  s_mov_b64 exec, -1
  s_add_u32 s71, s71, 1
  s_cmp_lt_u32 s71, 2
  s_cbranch_scc1 L_job_4
  s_branch L_exit
L_roleM:
  s_cmp_lg_u32 s5, 30
  s_cbranch_scc1 L_ncs_12
  s_cmp_lg_u32 s3, 0
  s_cbranch_scc1 L_ncs_12
  s_mul_i32 s7, s67, 0x9E3779B1
  s_max_u32 s7, s7, 1
  v_mov_b32 v2, s7
  v_mov_b32 v3, 0
  s_mov_b64 exec, 1
  buffer_atomic_cmpswap v[2:3], v6, s[52:55], 0 offen sc1
  s_mov_b64 exec, -1
L_ncs_12:
  s_sub_u32 s7, s5, 28
  s_mov_b32 s75, 0
  s_cmp_ge_u32 s4, 4
  s_cbranch_scc1 L_mm_13
  s_lshl_b32 s70, s4, 2
  s_add_u32 s70, s70, s7
  s_branch L_mm_14
L_mm_13:
  s_cmp_eq_u32 s7, 3
  s_cbranch_scc1 L_exit
  s_sub_u32 s70, s4, 4
  s_cmp_eq_u32 s7, 2
  s_cbranch_scc0 L_mm_15
  s_add_u32 s70, s70, 16
  s_branch L_mm_14
L_mm_15:
  s_lshl_b32 s70, s70, 1
  s_add_u32 s70, s70, s7
  s_cmp_eq_u32 s70, 7
  s_cselect_b32 s75, 0, 1
  s_cselect_b32 s7, 1, 0
  s_cmp_eq_u32 s7, 1
  s_cselect_b32 s70, 20, s70
  s_cbranch_scc1 L_mm_14
  s_lshl_b32 s70, s70, 2
  s_add_u32 s70, s70, 3
  s_branch L_mm_16
L_mm_14:
  s_mul_i32 s7, s70, 43
  s_lshr_b32 s7, s7, 7
  s_add_u32 s70, s70, s7
L_mm_16:
  s_mov_b32 s12, s28
  s_mov_b32 s13, s29
  s_mov_b32 s14, 1835008
  s_mov_b32 s15, 0x20000
  s_mov_b32 s44, s30
  s_mov_b32 s45, s31
  s_mov_b32 s46, 1835008
  s_mov_b32 s47, 0x20000
  s_mov_b32 s48, s32
  s_mov_b32 s49, s33
  s_mov_b32 s50, 1835008
  s_mov_b32 s51, 0x20000
  v_lshrrev_b32 v14, 3, v1
  s_mov_b32 s7, 3584
  v_mul_lo_u32 v14, v14, s7
  v_bfe_u32 v8, v1, 1, 2
  v_bfe_u32 v9, v1, 4, 2
  v_xor_b32 v8, v8, v9
  v_lshl_add_u32 v14, v8, 5, v14
  v_and_b32 v8, 1, v1
  v_lshl_add_u32 v14, v8, 4, v14
  v_lshrrev_b32 v12, 3, v1
  v_lshlrev_b32 v12, 8, v12
  v_and_b32 v8, 3, v1
  v_lshl_add_u32 v12, v8, 4, v12
  v_bfe_u32 v8, v1, 2, 1
  v_lshl_add_u32 v12, v8, 3, v12
  s_lshl_b32 s7, s3, 6
  s_add_u32 s7, s7, 131072
  v_add_u32 v12, s7, v12
  v_and_b32 v13, 3, v1
  v_lshlrev_b32 v13, 6, v13
  v_lshrrev_b32 v8, 4, v1
  v_lshl_add_u32 v13, v8, 4, v13
  v_add_u32 v13, 131072, v13
  v_lshrrev_b32 v15, 2, v1
  v_lshlrev_b32 v15, 7, v15
  v_bfe_u32 v8, v1, 3, 2
  v_xor_b32 v8, s3, v8
  v_lshl_add_u32 v15, v8, 5, v15
  v_and_b32 v8, 3, v1
  v_lshl_add_u32 v15, v8, 3, v15
  v_add_u32 v16, 65536, v15
  s_lshl_b32 s7, s3, 11
  v_lshl_add_u32 v17, v1, 4, s7
  v_and_b32 v20, 3, v1
  v_lshlrev_b32 v20, 6, v20
  v_lshrrev_b32 v8, 4, v1
  v_lshl_add_u32 v20, v8, 4, v20
  v_add_u32 v20, 135168, v20
  s_lshr_b32 s7, s3, 1
  s_lshl_b32 s7, s7, 8
  s_and_b32 s68, s3, 1
  s_lshl_b32 s68, s68, 3
  s_add_u32 s7, s7, s68
  v_add_u32 v19, s7, v20
  v_lshrrev_b32 v8, 5, v1
  v_mul_u32_u24 v18, 3584, v8
  v_bfe_u32 v8, v1, 4, 1
  v_lshl_add_u32 v18, v8, 6, v18
  v_and_b32 v8, 15, v1
  v_lshl_add_u32 v18, v8, 4, v18
  v_and_b32 v8, 12, v1
  v_add_u32 v8, 12, v8
  v_and_b32 v8, 16, v8
  v_lshl_or_b32 v18, v8, 27, v18
  s_cmp_ge_u32 s4, 4
  s_cbranch_scc1 L_nh_17
  s_mov_b32 s52, s36
  s_mov_b32 s53, s37
  s_mov_b32 s54, 3145728
  s_mov_b32 s55, 0x20000
  v_lshrrev_b32 v16, 3, v1
  s_mov_b32 s7, 6144
  v_mul_lo_u32 v16, v16, s7
  v_bfe_u32 v8, v1, 1, 2
  v_bfe_u32 v9, v1, 4, 2
  v_xor_b32 v8, v8, v9
  v_lshl_add_u32 v16, v8, 5, v16
  v_and_b32 v8, 1, v1
  v_lshl_add_u32 v16, v8, 4, v16
  s_sub_u32 s7, s5, 28
  s_mov_b32 s73, s7
  s_mov_b32 s74, 0
  s_cmp_lg_u32 s4, 1
  s_cbranch_scc1 L_sh_18
  s_lshr_b32 s73, s7, 1
  s_add_u32 s73, s73, 2
  s_and_b32 s74, s7, 1
  s_xor_b32 s74, s74, 1
  s_mul_i32 s74, s74, -786432
L_sh_18:
  s_and_b32 s69, s73, 1
  s_lshl_b32 s69, s69, 10
  s_lshr_b32 s7, s73, 1
  s_lshl_b32 s68, s4, 1
  s_add_u32 s7, s7, s68
  s_lshl_b32 s7, s7, 7
  s_add_u32 s69, s69, s7
  s_add_u32 s69, s69, s74
  s_mul_i32 s68, s3, 196608
  s_add_u32 s68, s68, s69
  s_add_u32 s68, s68, 2359296
  s_lshl_b32 s7, s3, 12
  s_add_u32 s7, s7, 49152
  s_mov_b32 m0, s7
  s_nop 0
  buffer_load_dwordx4 v16, s[52:55], s68 offen  lds
  s_add_u32 m0, m0, 1024
  s_add_u32 s68, s68, 49152
  buffer_load_dwordx4 v16, s[52:55], s68 offen  lds
  s_add_u32 m0, m0, 1024
  s_add_u32 s68, s68, 49152
  buffer_load_dwordx4 v16, s[52:55], s68 offen  lds
  s_add_u32 m0, m0, 1024
  s_add_u32 s68, s68, 49152
  buffer_load_dwordx4 v16, s[52:55], s68 offen  lds
  s_cmp_ge_u32 s5, 31
  s_cbranch_scc1 L_nq_19
  s_mov_b32 s52, s22
  s_mov_b32 s53, s23
  s_mov_b32 s54, 4194304
  s_mov_b32 s55, 0x20000
  v_lshrrev_b32 v16, 3, v1
  s_mov_b32 s7, 8192
  v_mul_lo_u32 v16, v16, s7
  v_bfe_u32 v8, v1, 1, 2
  v_bfe_u32 v9, v1, 4, 2
  v_xor_b32 v8, v8, v9
  v_lshl_add_u32 v16, v8, 5, v16
  v_and_b32 v8, 1, v1
  v_lshl_add_u32 v16, v8, 4, v16
  s_lshl_b32 s69, s4, 10
  s_add_u32 s69, s69, 384
  s_sub_u32 s7, s5, 29
  s_mul_i32 s7, s7, 1048576
  s_add_u32 s69, s69, s7
  s_mul_i32 s68, s3, 262144
  s_add_u32 s68, s68, s69
  s_add_u32 s68, s68, 2097152
  s_lshl_b32 s7, s3, 12
  s_add_u32 s7, s7, 98304
  s_mov_b32 m0, s7
  s_nop 0
  buffer_load_dwordx4 v16, s[52:55], s68 offen  lds
  s_add_u32 m0, m0, 1024
  s_add_u32 s68, s68, 65536
  buffer_load_dwordx4 v16, s[52:55], s68 offen  lds
  s_add_u32 m0, m0, 1024
  s_add_u32 s68, s68, 65536
  buffer_load_dwordx4 v16, s[52:55], s68 offen  lds
  s_add_u32 m0, m0, 1024
  s_add_u32 s68, s68, 65536
  buffer_load_dwordx4 v16, s[52:55], s68 offen  lds
L_nq_19:
  s_mov_b32 s52, s40
  s_mov_b32 s53, s41
  s_mov_b32 s54, 256
  s_mov_b32 s55, 0x20000
  v_add_u32 v16, 65536, v15
L_nh_17:
  v_lshlrev_b32 v9, 6, v1
  s_cmp_ge_u32 s5, 31
  s_cbranch_scc1 L_pw_20
  s_sub_u32 s73, s5, 28
  s_lshl_b32 s73, s73, 2
  s_add_u32 s73, s73, s3
  v_mov_b32 v8, v9
  s_cmp_ge_u32 s73, 10
  s_cbranch_scc1 L_pw_22
  s_cmp_ge_u32 s73, 8
  s_cbranch_scc1 L_pw_21
  s_lshr_b32 s74, s73, 1
  s_lshl_b32 s74, s74, 3
  s_add_u32 s74, s74, s4
  s_lshl_b32 s74, s74, 13
  s_and_b32 s7, s73, 1
  s_lshl_b32 s7, s7, 12
  s_add_u32 s74, s74, s7
  s_add_u32 s74, s74, 2228224
  s_branch L_pw_23
L_pw_21:
  s_lshl_b32 s74, s4, 13
  s_and_b32 s7, s73, 1
  s_lshl_b32 s7, s7, 12
  s_add_u32 s74, s74, s7
  s_add_u32 s74, s74, 2883584
  s_branch L_pw_23
L_pw_22:
  v_and_b32 v8, 31, v1
  v_lshlrev_b32 v8, 6, v8
  v_lshrrev_b32 v26, 5, v1
  v_lshl_add_u32 v8, v26, 14, v8
  s_and_b32 s74, s73, 1
  s_lshl_b32 s74, s74, 4
  s_add_u32 s74, s74, s4
  s_lshl_b32 s74, s74, 11
  s_add_u32 s74, s74, 2162688
L_pw_23:
  buffer_load_dword v27, v8, s[8:11], s74 offen
  v_bfe_u32 v8, v1, 2, 2
  v_lshlrev_b32 v8, 11, v8
  v_and_b32 v26, 3, v1
  v_lshl_add_u32 v8, v26, 6, v8
  s_lshl_b32 s74, s4, 8
  s_add_u32 s74, s74, 2490368
  buffer_load_dword v28, v8, s[8:11], s74 offen
L_pw_20:
  s_cmp_lg_u32 s5, 28
  s_cbranch_scc1 L_pc_24
  s_getpc_b64 s[76:77]
L_pc_25:
  s_sub_u32 s76, s76, L_pc_25-adaLN_cond__sliding_block_cached__glu_gated_glu__decode_kernel
  s_subb_u32 s77, s77, 0
  v_lshlrev_b32 v9, 6, v1
  s_lshl_b32 s7, s3, 12
  v_add_u32 v9, s7, v9
  v_mov_b32 v8, L_end-adaLN_cond__sliding_block_cached__glu_gated_glu__decode_kernel
  v_cmp_lt_u32 vcc, v9, v8
  s_and_saveexec_b64 s[62:63], vcc
  s_cbranch_execz L_pc_26
  global_load_dword v29, v9, s[76:77]
L_pc_26:
  s_mov_b64 exec, s[62:63]
  v_add_u32 v9, 16384, v9
  v_cmp_lt_u32 vcc, v9, v8
  s_and_saveexec_b64 s[62:63], vcc
  s_cbranch_execz L_pc_27
  global_load_dword v30, v9, s[76:77]
L_pc_27:
  s_mov_b64 exec, s[62:63]
L_pc_24:
  buffer_load_dword v2, v6, s[52:55], 0 offen sc1
  s_waitcnt vmcnt(0)
  s_mov_b32 s66, 0
L_non_28:
  v_readfirstlane_b32 s6, v2
  s_cmp_lg_u32 s6, 0
  s_cbranch_scc1 L_nok_29
  buffer_load_dword v2, v6, s[52:55], 0 offen sc1
  s_add_u32 s66, s66, 1
  s_cmp_lt_u32 s66, 200000
  s_cbranch_scc0 L_exit
  s_waitcnt vmcnt(0)
  s_branch L_non_28
L_nok_29:
  v_mov_b32 v2, s6
  s_and_b32 s98, s6, 0xff
  s_bfe_u32 s99, s6, 524296
  s_bfe_u32 s100, s6, 524304
  s_bfe_u32 s101, s6, 524312
  s_cmp_eq_u32 s75, 1
  s_cbranch_scc1 L_mt_30
  s_lshl_b32 s76, s4, 10
  s_add_u32 s76, s76, 0
  s_mov_b32 s66, 0
L_poll_31:
  buffer_load_dwordx4 v[32:35], v6, s[8:11], s76 offen sc1
  s_waitcnt vmcnt(0)
  v_xor_b32 v32, s98, v32
  v_xor_b32 v33, s99, v33
  v_xor_b32 v34, s100, v34
  v_xor_b32 v35, s101, v35
  v_or3_b32 v8, v32, v33, v34
  v_or_b32 v8, v8, v35
  v_cmp_ne_u32_sdwa vcc, v8, v6 src0_sel:BYTE_0 src1_sel:DWORD
  s_cbranch_vccz L_ok_32
  s_add_u32 s66, s66, 1
  s_cmp_lt_u32 s66, 200000
  s_cbranch_scc1 L_poll_31
  s_branch L_exit
L_ok_32:
L_mt_30:
  s_lshl_b32 s69, s70, 7
  s_mul_i32 s68, s3, 114688
  s_add_u32 s68, s68, s69
  s_lshl_b32 s7, s3, 12
  s_add_u32 s7, s7, 0
  s_mov_b32 m0, s7
  s_nop 0
  buffer_load_dwordx4 v14, s[12:15], s68 offen nt lds
  s_add_u32 m0, m0, 1024
  s_add_u32 s68, s68, 28672
  buffer_load_dwordx4 v14, s[12:15], s68 offen nt lds
  s_add_u32 m0, m0, 1024
  s_add_u32 s68, s68, 28672
  buffer_load_dwordx4 v14, s[12:15], s68 offen nt lds
  s_add_u32 m0, m0, 1024
  s_add_u32 s68, s68, 28672
  buffer_load_dwordx4 v14, s[12:15], s68 offen nt lds
  s_add_u32 m0, m0, 13312
  s_add_u32 s68, s68, 372736
  buffer_load_dwordx4 v14, s[12:15], s68 offen nt lds
  s_add_u32 m0, m0, 1024
  s_add_u32 s68, s68, 28672
  buffer_load_dwordx4 v14, s[12:15], s68 offen nt lds
  s_add_u32 m0, m0, 1024
  s_add_u32 s68, s68, 28672
  buffer_load_dwordx4 v14, s[12:15], s68 offen nt lds
  s_add_u32 m0, m0, 1024
  s_add_u32 s68, s68, 28672
  buffer_load_dwordx4 v14, s[12:15], s68 offen nt lds
  s_add_u32 m0, m0, 13312
  s_add_u32 s68, s68, 372736
  buffer_load_dwordx4 v14, s[12:15], s68 offen nt lds
  s_add_u32 m0, m0, 1024
  s_add_u32 s68, s68, 28672
  buffer_load_dwordx4 v14, s[12:15], s68 offen nt lds
  s_add_u32 m0, m0, 1024
  s_add_u32 s68, s68, 28672
  buffer_load_dwordx4 v14, s[12:15], s68 offen nt lds
  s_add_u32 m0, m0, 1024
  s_add_u32 s68, s68, 28672
  buffer_load_dwordx4 v14, s[12:15], s68 offen nt lds
  s_add_u32 m0, m0, 13312
  s_add_u32 s68, s68, 372736
  buffer_load_dwordx4 v14, s[12:15], s68 offen nt lds
  s_add_u32 m0, m0, 1024
  s_add_u32 s68, s68, 28672
  buffer_load_dwordx4 v14, s[12:15], s68 offen nt lds
  s_add_u32 m0, m0, 1024
  s_add_u32 s68, s68, 28672
  buffer_load_dwordx4 v14, s[12:15], s68 offen nt lds
  s_add_u32 m0, m0, 1024
  s_add_u32 s68, s68, 28672
  buffer_load_dwordx4 v14, s[12:15], s68 offen nt lds
  s_mul_i32 s68, s3, 114688
  s_add_u32 s68, s68, s69
  s_lshl_b32 s7, s3, 12
  s_add_u32 s7, s7, 65536
  s_mov_b32 m0, s7
  s_nop 0
  buffer_load_dwordx4 v14, s[44:47], s68 offen nt lds
  s_add_u32 m0, m0, 1024
  s_add_u32 s68, s68, 28672
  buffer_load_dwordx4 v14, s[44:47], s68 offen nt lds
  s_add_u32 m0, m0, 1024
  s_add_u32 s68, s68, 28672
  buffer_load_dwordx4 v14, s[44:47], s68 offen nt lds
  s_add_u32 m0, m0, 1024
  s_add_u32 s68, s68, 28672
  buffer_load_dwordx4 v14, s[44:47], s68 offen nt lds
  s_add_u32 m0, m0, 13312
  s_add_u32 s68, s68, 372736
  buffer_load_dwordx4 v14, s[44:47], s68 offen nt lds
  s_add_u32 m0, m0, 1024
  s_add_u32 s68, s68, 28672
  buffer_load_dwordx4 v14, s[44:47], s68 offen nt lds
  s_add_u32 m0, m0, 1024
  s_add_u32 s68, s68, 28672
  buffer_load_dwordx4 v14, s[44:47], s68 offen nt lds
  s_add_u32 m0, m0, 1024
  s_add_u32 s68, s68, 28672
  buffer_load_dwordx4 v14, s[44:47], s68 offen nt lds
  s_add_u32 m0, m0, 13312
  s_add_u32 s68, s68, 372736
  buffer_load_dwordx4 v14, s[44:47], s68 offen nt lds
  s_add_u32 m0, m0, 1024
  s_add_u32 s68, s68, 28672
  buffer_load_dwordx4 v14, s[44:47], s68 offen nt lds
  s_add_u32 m0, m0, 1024
  s_add_u32 s68, s68, 28672
  buffer_load_dwordx4 v14, s[44:47], s68 offen nt lds
  s_add_u32 m0, m0, 1024
  s_add_u32 s68, s68, 28672
  buffer_load_dwordx4 v14, s[44:47], s68 offen nt lds
  s_add_u32 m0, m0, 13312
  s_add_u32 s68, s68, 372736
  buffer_load_dwordx4 v14, s[44:47], s68 offen nt lds
  s_add_u32 m0, m0, 1024
  s_add_u32 s68, s68, 28672
  buffer_load_dwordx4 v14, s[44:47], s68 offen nt lds
  s_add_u32 m0, m0, 1024
  s_add_u32 s68, s68, 28672
  buffer_load_dwordx4 v14, s[44:47], s68 offen nt lds
  s_add_u32 m0, m0, 1024
  s_add_u32 s68, s68, 28672
  buffer_load_dwordx4 v14, s[44:47], s68 offen nt lds
  s_waitcnt vmcnt(16)
  s_barrier
  ds_read_b64_tr_b16 a[0:1], v15 offset:0
  ds_read_b64_tr_b16 a[2:3], v15 offset:2048
  ds_read_b64_tr_b16 a[4:5], v15 offset:4096
  ds_read_b64_tr_b16 a[6:7], v15 offset:6144
  ds_read_b64_tr_b16 a[8:9], v15 offset:8192
  ds_read_b64_tr_b16 a[10:11], v15 offset:10240
  ds_read_b64_tr_b16 a[12:13], v15 offset:12288
  ds_read_b64_tr_b16 a[14:15], v15 offset:14336
  s_waitcnt lgkmcnt(0)
  ds_read_b64_tr_b16 a[16:17], v15 offset:16384
  ds_read_b64_tr_b16 a[18:19], v15 offset:18432
  ds_read_b64_tr_b16 a[20:21], v15 offset:20480
  ds_read_b64_tr_b16 a[22:23], v15 offset:22528
  ds_read_b64_tr_b16 a[24:25], v15 offset:24576
  ds_read_b64_tr_b16 a[26:27], v15 offset:26624
  ds_read_b64_tr_b16 a[28:29], v15 offset:28672
  ds_read_b64_tr_b16 a[30:31], v15 offset:30720
  s_waitcnt lgkmcnt(0)
  ds_read_b64_tr_b16 a[32:33], v15 offset:32768
  ds_read_b64_tr_b16 a[34:35], v15 offset:34816
  ds_read_b64_tr_b16 a[36:37], v15 offset:36864
  ds_read_b64_tr_b16 a[38:39], v15 offset:38912
  ds_read_b64_tr_b16 a[40:41], v15 offset:40960
  ds_read_b64_tr_b16 a[42:43], v15 offset:43008
  ds_read_b64_tr_b16 a[44:45], v15 offset:45056
  ds_read_b64_tr_b16 a[46:47], v15 offset:47104
  s_waitcnt lgkmcnt(0)
  ds_read_b64_tr_b16 a[48:49], v15 offset:49152
  ds_read_b64_tr_b16 a[50:51], v15 offset:51200
  ds_read_b64_tr_b16 a[52:53], v15 offset:53248
  ds_read_b64_tr_b16 a[54:55], v15 offset:55296
  ds_read_b64_tr_b16 a[56:57], v15 offset:57344
  ds_read_b64_tr_b16 a[58:59], v15 offset:59392
  ds_read_b64_tr_b16 a[60:61], v15 offset:61440
  ds_read_b64_tr_b16 a[62:63], v15 offset:63488
  s_waitcnt lgkmcnt(0)
  s_barrier
  s_lshl_b32 s68, s70, 16
  s_lshl_b32 s7, s3, 14
  s_add_u32 s68, s68, s7
  s_add_u32 s7, s7, 0
  s_mov_b32 m0, s7
  v_lshlrev_b32 v9, 4, v1
  v_xor_b32 v8, 0, v9
  buffer_load_dwordx4 v8, s[48:51], s68 offen nt lds
  v_xor_b32 v8, 32, v9
  s_add_u32 m0, m0, 1024
  s_add_u32 s68, s68, 1024
  buffer_load_dwordx4 v8, s[48:51], s68 offen nt lds
  v_xor_b32 v8, 64, v9
  s_add_u32 m0, m0, 1024
  s_add_u32 s68, s68, 1024
  buffer_load_dwordx4 v8, s[48:51], s68 offen nt lds
  v_xor_b32 v8, 96, v9
  s_add_u32 m0, m0, 1024
  s_add_u32 s68, s68, 1024
  buffer_load_dwordx4 v8, s[48:51], s68 offen nt lds
  v_xor_b32 v8, 128, v9
  s_add_u32 m0, m0, 1024
  s_add_u32 s68, s68, 1024
  buffer_load_dwordx4 v8, s[48:51], s68 offen nt lds
  v_xor_b32 v8, 160, v9
  s_add_u32 m0, m0, 1024
  s_add_u32 s68, s68, 1024
  buffer_load_dwordx4 v8, s[48:51], s68 offen nt lds
  v_xor_b32 v8, 192, v9
  s_add_u32 m0, m0, 1024
  s_add_u32 s68, s68, 1024
  buffer_load_dwordx4 v8, s[48:51], s68 offen nt lds
  v_xor_b32 v8, 224, v9
  s_add_u32 m0, m0, 1024
  s_add_u32 s68, s68, 1024
  buffer_load_dwordx4 v8, s[48:51], s68 offen nt lds
  v_xor_b32 v8, 0, v9
  s_add_u32 m0, m0, 1024
  s_add_u32 s68, s68, 1024
  buffer_load_dwordx4 v8, s[48:51], s68 offen nt lds
  v_xor_b32 v8, 32, v9
  s_add_u32 m0, m0, 1024
  s_add_u32 s68, s68, 1024
  buffer_load_dwordx4 v8, s[48:51], s68 offen nt lds
  v_xor_b32 v8, 64, v9
  s_add_u32 m0, m0, 1024
  s_add_u32 s68, s68, 1024
  buffer_load_dwordx4 v8, s[48:51], s68 offen nt lds
  v_xor_b32 v8, 96, v9
  s_add_u32 m0, m0, 1024
  s_add_u32 s68, s68, 1024
  buffer_load_dwordx4 v8, s[48:51], s68 offen nt lds
  v_xor_b32 v8, 128, v9
  s_add_u32 m0, m0, 1024
  s_add_u32 s68, s68, 1024
  buffer_load_dwordx4 v8, s[48:51], s68 offen nt lds
  v_xor_b32 v8, 160, v9
  s_add_u32 m0, m0, 1024
  s_add_u32 s68, s68, 1024
  buffer_load_dwordx4 v8, s[48:51], s68 offen nt lds
  v_xor_b32 v8, 192, v9
  s_add_u32 m0, m0, 1024
  s_add_u32 s68, s68, 1024
  buffer_load_dwordx4 v8, s[48:51], s68 offen nt lds
  v_xor_b32 v8, 224, v9
  s_add_u32 m0, m0, 1024
  s_add_u32 s68, s68, 1024
  buffer_load_dwordx4 v8, s[48:51], s68 offen nt lds
  s_waitcnt vmcnt(16)
  s_barrier
  ds_read_b64_tr_b16 a[64:65], v16 offset:0
  ds_read_b64_tr_b16 a[66:67], v16 offset:2048
  ds_read_b64_tr_b16 a[68:69], v16 offset:4096
  ds_read_b64_tr_b16 a[70:71], v16 offset:6144
  ds_read_b64_tr_b16 a[72:73], v16 offset:8192
  ds_read_b64_tr_b16 a[74:75], v16 offset:10240
  ds_read_b64_tr_b16 a[76:77], v16 offset:12288
  ds_read_b64_tr_b16 a[78:79], v16 offset:14336
  s_waitcnt lgkmcnt(0)
  ds_read_b64_tr_b16 a[80:81], v16 offset:16384
  ds_read_b64_tr_b16 a[82:83], v16 offset:18432
  ds_read_b64_tr_b16 a[84:85], v16 offset:20480
  ds_read_b64_tr_b16 a[86:87], v16 offset:22528
  ds_read_b64_tr_b16 a[88:89], v16 offset:24576
  ds_read_b64_tr_b16 a[90:91], v16 offset:26624
  ds_read_b64_tr_b16 a[92:93], v16 offset:28672
  ds_read_b64_tr_b16 a[94:95], v16 offset:30720
  s_waitcnt lgkmcnt(0)
  ds_read_b64_tr_b16 a[96:97], v16 offset:32768
  ds_read_b64_tr_b16 a[98:99], v16 offset:34816
  ds_read_b64_tr_b16 a[100:101], v16 offset:36864
  ds_read_b64_tr_b16 a[102:103], v16 offset:38912
  ds_read_b64_tr_b16 a[104:105], v16 offset:40960
  ds_read_b64_tr_b16 a[106:107], v16 offset:43008
  ds_read_b64_tr_b16 a[108:109], v16 offset:45056
  ds_read_b64_tr_b16 a[110:111], v16 offset:47104
  s_waitcnt lgkmcnt(0)
  ds_read_b64_tr_b16 a[112:113], v16 offset:49152
  ds_read_b64_tr_b16 a[114:115], v16 offset:51200
  ds_read_b64_tr_b16 a[116:117], v16 offset:53248
  ds_read_b64_tr_b16 a[118:119], v16 offset:55296
  ds_read_b64_tr_b16 a[120:121], v16 offset:57344
  ds_read_b64_tr_b16 a[122:123], v16 offset:59392
  ds_read_b64_tr_b16 a[124:125], v16 offset:61440
  ds_read_b64_tr_b16 a[126:127], v16 offset:63488
  s_waitcnt lgkmcnt(0)
  s_lshl_b32 s7, s3, 4
  v_lshl_add_u32 v10, v1, 6, s7
  s_mov_b32 s71, 32768
  s_mov_b32 s72, 24576
  s_mov_b32 s73, 36864
  s_mov_b32 s74, 28672
  s_mov_b32 s66, 0
L_poll_33:
  buffer_load_dwordx4 v[44:47], v10, s[8:11], s71 offen sc1
  buffer_load_dwordx4 v[48:51], v10, s[8:11], s73 offen sc1
  buffer_load_dwordx4 v[52:55], v10, s[8:11], s72 offen sc1
  buffer_load_dwordx4 v[56:59], v10, s[8:11], s74 offen sc1
  s_waitcnt vmcnt(0)
  v_xor_b32 v44, s98, v44
  v_xor_b32 v45, s99, v45
  v_xor_b32 v46, s100, v46
  v_xor_b32 v47, s101, v47
  v_xor_b32 v48, s98, v48
  v_xor_b32 v49, s99, v49
  v_xor_b32 v50, s100, v50
  v_xor_b32 v51, s101, v51
  v_xor_b32 v52, s98, v52
  v_xor_b32 v53, s99, v53
  v_xor_b32 v54, s100, v54
  v_xor_b32 v55, s101, v55
  v_xor_b32 v56, s98, v56
  v_xor_b32 v57, s99, v57
  v_xor_b32 v58, s100, v58
  v_xor_b32 v59, s101, v59
  v_or3_b32 v8, v44, v45, v46
  v_or3_b32 v8, v8, v47, v48
  v_or3_b32 v8, v8, v49, v50
  v_or3_b32 v8, v8, v51, v52
  v_or3_b32 v8, v8, v53, v54
  v_or3_b32 v8, v8, v55, v56
  v_or3_b32 v8, v8, v57, v58
  v_or_b32 v8, v8, v59
  v_cmp_ne_u32_sdwa vcc, v8, v6 src0_sel:BYTE_0 src1_sel:DWORD
  s_cbranch_vccz L_ok_34
  s_add_u32 s66, s66, 1
  s_cmp_lt_u32 s66, 200000
  s_cbranch_scc1 L_poll_33
  s_branch L_exit
L_ok_34:
  v_add_f32 v44, 1.0, v44
  v_add_f32 v45, 1.0, v45
  v_add_f32 v46, 1.0, v46
  v_add_f32 v47, 1.0, v47
  v_add_f32 v48, 1.0, v48
  v_add_f32 v49, 1.0, v49
  v_add_f32 v50, 1.0, v50
  v_add_f32 v51, 1.0, v51
  s_barrier
  v_lshrrev_b32 v15, 2, v1
  v_and_b32 v8, 7, v15
  v_lshlrev_b32 v15, 10, v15
  v_lshl_add_u32 v15, v8, 5, v15
  v_and_b32 v8, 3, v1
  v_lshl_add_u32 v15, v8, 3, v15
  s_lshl_b32 s7, s3, 8
  s_add_u32 s7, s7, 0
  v_add_u32 v15, s7, v15
  v_xor_b32 v8, 0, v15
  ds_read_b64_tr_b16 a[128:129], v8 offset:0
  ds_read_b64_tr_b16 a[130:131], v8 offset:16384
  ds_read_b64_tr_b16 a[132:133], v8 offset:32768
  ds_read_b64_tr_b16 a[134:135], v8 offset:49152
  v_xor_b32 v8, 32, v15
  ds_read_b64_tr_b16 a[136:137], v8 offset:0
  ds_read_b64_tr_b16 a[138:139], v8 offset:16384
  ds_read_b64_tr_b16 a[140:141], v8 offset:32768
  ds_read_b64_tr_b16 a[142:143], v8 offset:49152
  s_waitcnt lgkmcnt(0)
  v_xor_b32 v8, 64, v15
  ds_read_b64_tr_b16 a[144:145], v8 offset:0
  ds_read_b64_tr_b16 a[146:147], v8 offset:16384
  ds_read_b64_tr_b16 a[148:149], v8 offset:32768
  ds_read_b64_tr_b16 a[150:151], v8 offset:49152
  v_xor_b32 v8, 96, v15
  ds_read_b64_tr_b16 a[152:153], v8 offset:0
  ds_read_b64_tr_b16 a[154:155], v8 offset:16384
  ds_read_b64_tr_b16 a[156:157], v8 offset:32768
  ds_read_b64_tr_b16 a[158:159], v8 offset:49152
  s_waitcnt lgkmcnt(0)
  v_xor_b32 v8, 128, v15
  ds_read_b64_tr_b16 a[160:161], v8 offset:0
  ds_read_b64_tr_b16 a[162:163], v8 offset:16384
  ds_read_b64_tr_b16 a[164:165], v8 offset:32768
  ds_read_b64_tr_b16 a[166:167], v8 offset:49152
  v_xor_b32 v8, 160, v15
  ds_read_b64_tr_b16 a[168:169], v8 offset:0
  ds_read_b64_tr_b16 a[170:171], v8 offset:16384
  ds_read_b64_tr_b16 a[172:173], v8 offset:32768
  ds_read_b64_tr_b16 a[174:175], v8 offset:49152
  s_waitcnt lgkmcnt(0)
  v_xor_b32 v8, 192, v15
  ds_read_b64_tr_b16 a[176:177], v8 offset:0
  ds_read_b64_tr_b16 a[178:179], v8 offset:16384
  ds_read_b64_tr_b16 a[180:181], v8 offset:32768
  ds_read_b64_tr_b16 a[182:183], v8 offset:49152
  v_xor_b32 v8, 224, v15
  ds_read_b64_tr_b16 a[184:185], v8 offset:0
  ds_read_b64_tr_b16 a[186:187], v8 offset:16384
  ds_read_b64_tr_b16 a[188:189], v8 offset:32768
  ds_read_b64_tr_b16 a[190:191], v8 offset:49152
  s_waitcnt lgkmcnt(0)
  s_mul_i32 s68, s3, 57344
  s_lshl_b32 s7, s70, 7
  s_add_u32 s68, s68, s7
  s_add_u32 s68, s68, 851968
  s_lshl_b32 s71, s4, 13
  s_add_u32 s71, s71, 786432
  s_mov_b32 s66, 0
L_poll_35:
  s_and_b32 s7, s66, 15
  s_cmp_eq_u32 s7, 15
  s_cselect_b32 s7, 0, 2097152
  s_add_u32 s72, s71, s7
  buffer_load_dwordx4 v[24:27], v17, s[8:11], s72 offen sc1
  buffer_load_dwordx4 v[28:31], v17, s[8:11], s72 offen offset:1024 sc1
  s_waitcnt vmcnt(0)
  v_xor_b32 v24, s98, v24
  v_xor_b32 v25, s99, v25
  v_xor_b32 v26, s100, v26
  v_xor_b32 v27, s101, v27
  v_xor_b32 v28, s98, v28
  v_xor_b32 v29, s99, v29
  v_xor_b32 v30, s100, v30
  v_xor_b32 v31, s101, v31
  v_or3_b32 v8, v24, v25, v26
  v_or3_b32 v8, v8, v27, v28
  v_or3_b32 v8, v8, v29, v30
  v_or_b32 v8, v8, v31
  v_cmp_ne_u32_sdwa vcc, v8, v6 src0_sel:BYTE_0 src1_sel:DWORD
  s_cbranch_vccz L_ok_36
  s_add_u32 s66, s66, 1
  s_cmp_lt_u32 s66, 200000
  s_cbranch_scc1 L_poll_35
  s_branch L_exit
L_ok_36:
  v_pk_mul_f32 v[8:9], v[24:25], v[24:25]
  v_pk_add_f32 v[10:11], v[24:25], v[26:27]
  v_pk_fma_f32 v[8:9], v[26:27], v[26:27], v[8:9]
  v_pk_add_f32 v[10:11], v[10:11], v[28:29]
  v_pk_fma_f32 v[8:9], v[28:29], v[28:29], v[8:9]
  v_pk_add_f32 v[10:11], v[10:11], v[30:31]
  v_pk_fma_f32 v[8:9], v[30:31], v[30:31], v[8:9]
  v_add_f32 v10, v10, v11
  v_add_f32 v11, v8, v9
  s_nop 0
  v_add_f32_dpp v10, v10, v10 quad_perm:[1,0,3,2] row_mask:0xf bank_mask:0xf
  v_add_f32_dpp v11, v11, v11 quad_perm:[1,0,3,2] row_mask:0xf bank_mask:0xf
  s_nop 0
  v_add_f32_dpp v10, v10, v10 quad_perm:[2,3,0,1] row_mask:0xf bank_mask:0xf
  v_add_f32_dpp v11, v11, v11 quad_perm:[2,3,0,1] row_mask:0xf bank_mask:0xf
  s_nop 0
  v_add_f32_dpp v10, v10, v10 row_half_mirror row_mask:0xf bank_mask:0xf
  v_add_f32_dpp v11, v11, v11 row_half_mirror row_mask:0xf bank_mask:0xf
  s_nop 0
  v_add_f32_dpp v10, v10, v10 row_mirror row_mask:0xf bank_mask:0xf
  v_add_f32_dpp v11, v11, v11 row_mirror row_mask:0xf bank_mask:0xf
  s_nop 1
  v_permlane16_swap_b32 v10, v11
  v_add_f32 v10, v10, v11
  v_mov_b32 v11, v10
  s_nop 1
  v_permlane32_swap_b32 v11, v10
  v_add_f32 v10, v10, v11
  v_mov_b32 v11, v10
  s_nop 1
  v_permlane16_swap_b32 v10, v11
  v_mul_f32 v10, 0x3b000000, v10
  v_mul_f32 v11, 0x3b000000, v11
  v_fma_f32 v11, -v10, v10, v11
  v_max_f32 v11, 0, v11
  v_add_f32 v11, 0x3727c5ac, v11
  v_rsq_f32 v11, v11
  s_nop 0
  v_pk_add_f32 v[24:25], v[24:25], v[10:11] op_sel_hi:[1,0] neg_lo:[0,1] neg_hi:[0,1]
  v_pk_add_f32 v[26:27], v[26:27], v[10:11] op_sel_hi:[1,0] neg_lo:[0,1] neg_hi:[0,1]
  v_pk_add_f32 v[28:29], v[28:29], v[10:11] op_sel_hi:[1,0] neg_lo:[0,1] neg_hi:[0,1]
  v_pk_add_f32 v[30:31], v[30:31], v[10:11] op_sel_hi:[1,0] neg_lo:[0,1] neg_hi:[0,1]
  v_pk_mul_f32 v[44:45], v[44:45], v[10:11] op_sel:[0,1] op_sel_hi:[1,1]
  v_pk_mul_f32 v[46:47], v[46:47], v[10:11] op_sel:[0,1] op_sel_hi:[1,1]
  v_pk_mul_f32 v[48:49], v[48:49], v[10:11] op_sel:[0,1] op_sel_hi:[1,1]
  v_pk_mul_f32 v[50:51], v[50:51], v[10:11] op_sel:[0,1] op_sel_hi:[1,1]
  v_pk_fma_f32 v[24:25], v[24:25], v[44:45], v[52:53]
  v_pk_fma_f32 v[26:27], v[26:27], v[46:47], v[54:55]
  v_pk_fma_f32 v[28:29], v[28:29], v[48:49], v[56:57]
  v_pk_fma_f32 v[30:31], v[30:31], v[50:51], v[58:59]
  v_cvt_pk_bf16_f32 v32, v24, v25
  v_cvt_pk_bf16_f32 v33, v26, v27
  v_cvt_pk_bf16_f32 v34, v28, v29
  v_cvt_pk_bf16_f32 v35, v30, v31
  ds_write_b64 v12, v[32:33]
  ds_write_b64 v12, v[34:35] offset:2048
  s_waitcnt lgkmcnt(0)
  s_barrier
  ds_read_b128 v[60:63], v13 offset:0
  ds_read_b128 v[64:67], v13 offset:256
  ds_read_b128 v[68:71], v13 offset:512
  ds_read_b128 v[72:75], v13 offset:768
  ds_read_b128 v[76:79], v13 offset:1024
  ds_read_b128 v[80:83], v13 offset:1280
  ds_read_b128 v[84:87], v13 offset:1536
  ds_read_b128 v[88:91], v13 offset:1792
  s_waitcnt lgkmcnt(7)
  v_mfma_f32_16x16x32_bf16 v[36:39], a[0:3], v[60:63], 0
  v_mfma_f32_16x16x32_bf16 v[40:43], a[64:67], v[60:63], 0
  ds_read_b128 v[92:95], v13 offset:2048
  s_waitcnt lgkmcnt(7)
  v_mfma_f32_16x16x32_bf16 v[36:39], a[4:7], v[64:67], v[36:39]
  v_mfma_f32_16x16x32_bf16 v[40:43], a[68:71], v[64:67], v[40:43]
  ds_read_b128 v[96:99], v13 offset:2304
  s_waitcnt lgkmcnt(7)
  v_mfma_f32_16x16x32_bf16 v[36:39], a[8:11], v[68:71], v[36:39]
  v_mfma_f32_16x16x32_bf16 v[40:43], a[72:75], v[68:71], v[40:43]
  ds_read_b128 v[100:103], v13 offset:2560
  s_waitcnt lgkmcnt(7)
  v_mfma_f32_16x16x32_bf16 v[36:39], a[12:15], v[72:75], v[36:39]
  v_mfma_f32_16x16x32_bf16 v[40:43], a[76:79], v[72:75], v[40:43]
  ds_read_b128 v[104:107], v13 offset:2816
  s_waitcnt lgkmcnt(7)
  v_mfma_f32_16x16x32_bf16 v[36:39], a[16:19], v[76:79], v[36:39]
  v_mfma_f32_16x16x32_bf16 v[40:43], a[80:83], v[76:79], v[40:43]
  ds_read_b128 v[108:111], v13 offset:3072
  s_waitcnt lgkmcnt(7)
  v_mfma_f32_16x16x32_bf16 v[36:39], a[20:23], v[80:83], v[36:39]
  v_mfma_f32_16x16x32_bf16 v[40:43], a[84:87], v[80:83], v[40:43]
  ds_read_b128 v[112:115], v13 offset:3328
  s_waitcnt lgkmcnt(7)
  v_mfma_f32_16x16x32_bf16 v[36:39], a[24:27], v[84:87], v[36:39]
  v_mfma_f32_16x16x32_bf16 v[40:43], a[88:91], v[84:87], v[40:43]
  ds_read_b128 v[116:119], v13 offset:3584
  s_waitcnt lgkmcnt(7)
  v_mfma_f32_16x16x32_bf16 v[36:39], a[28:31], v[88:91], v[36:39]
  v_mfma_f32_16x16x32_bf16 v[40:43], a[92:95], v[88:91], v[40:43]
  ds_read_b128 v[120:123], v13 offset:3840
  s_waitcnt lgkmcnt(7)
  v_mfma_f32_16x16x32_bf16 v[36:39], a[32:35], v[92:95], v[36:39]
  v_mfma_f32_16x16x32_bf16 v[40:43], a[96:99], v[92:95], v[40:43]
  s_waitcnt lgkmcnt(6)
  v_mfma_f32_16x16x32_bf16 v[36:39], a[36:39], v[96:99], v[36:39]
  v_mfma_f32_16x16x32_bf16 v[40:43], a[100:103], v[96:99], v[40:43]
  s_waitcnt lgkmcnt(5)
  v_mfma_f32_16x16x32_bf16 v[36:39], a[40:43], v[100:103], v[36:39]
  v_mfma_f32_16x16x32_bf16 v[40:43], a[104:107], v[100:103], v[40:43]
  s_waitcnt lgkmcnt(4)
  v_mfma_f32_16x16x32_bf16 v[36:39], a[44:47], v[104:107], v[36:39]
  v_mfma_f32_16x16x32_bf16 v[40:43], a[108:111], v[104:107], v[40:43]
  s_waitcnt lgkmcnt(3)
  v_mfma_f32_16x16x32_bf16 v[36:39], a[48:51], v[108:111], v[36:39]
  v_mfma_f32_16x16x32_bf16 v[40:43], a[112:115], v[108:111], v[40:43]
  s_waitcnt lgkmcnt(2)
  v_mfma_f32_16x16x32_bf16 v[36:39], a[52:55], v[112:115], v[36:39]
  v_mfma_f32_16x16x32_bf16 v[40:43], a[116:119], v[112:115], v[40:43]
  s_waitcnt lgkmcnt(1)
  v_mfma_f32_16x16x32_bf16 v[36:39], a[56:59], v[116:119], v[36:39]
  v_mfma_f32_16x16x32_bf16 v[40:43], a[120:123], v[116:119], v[40:43]
  s_waitcnt lgkmcnt(0)
  v_mfma_f32_16x16x32_bf16 v[36:39], a[60:63], v[120:123], v[36:39]
  v_mfma_f32_16x16x32_bf16 v[40:43], a[124:127], v[120:123], v[40:43]
  s_nop 6
  v_mul_f32 v36, 0xbfb8aa3b, v36
  v_mul_f32 v37, 0xbfb8aa3b, v37
  v_mul_f32 v38, 0xbfb8aa3b, v38
  v_mul_f32 v39, 0xbfb8aa3b, v39
  v_exp_f32 v36, v36
  v_exp_f32 v37, v37
  v_exp_f32 v38, v38
  v_exp_f32 v39, v39
  v_add_f32 v36, 1.0, v36
  v_add_f32 v37, 1.0, v37
  v_add_f32 v38, 1.0, v38
  v_add_f32 v39, 1.0, v39
  v_rcp_f32 v36, v36
  v_rcp_f32 v37, v37
  v_rcp_f32 v38, v38
  v_rcp_f32 v39, v39
  v_pk_mul_f32 v[36:37], v[36:37], v[40:41]
  v_pk_mul_f32 v[38:39], v[38:39], v[42:43]
  v_cvt_pk_bf16_f32 v32, v36, v37
  v_cvt_pk_bf16_f32 v33, v38, v39
  ds_write_b64 v19, v[32:33]
  s_waitcnt lgkmcnt(0)
  s_barrier
  ds_read_b128 v[60:63], v20
  ds_read_b128 v[64:67], v20 offset:256
  s_waitcnt lgkmcnt(0)
  v_mfma_f32_16x16x32_bf16 v[124:127], a[128:131], v[60:63], 0
  v_mfma_f32_16x16x32_bf16 v[124:127], a[132:135], v[64:67], v[124:127]
  v_mfma_f32_16x16x32_bf16 v[128:131], a[136:139], v[60:63], 0
  v_mfma_f32_16x16x32_bf16 v[128:131], a[140:143], v[64:67], v[128:131]
  v_mfma_f32_16x16x32_bf16 v[132:135], a[144:147], v[60:63], 0
  v_mfma_f32_16x16x32_bf16 v[132:135], a[148:151], v[64:67], v[132:135]
  s_nop 3
  v_perm_b32 v68, v124, v2, s57
  v_perm_b32 v69, v125, v2, s58
  v_perm_b32 v70, v126, v2, s59
  v_perm_b32 v71, v127, v2, s60
  buffer_store_dwordx4 v[68:71], v18, s[8:11], s68 offen sc1
  s_add_u32 s68, s68, 7168
  v_mfma_f32_16x16x32_bf16 v[136:139], a[152:155], v[60:63], 0
  v_mfma_f32_16x16x32_bf16 v[136:139], a[156:159], v[64:67], v[136:139]
  v_perm_b32 v72, v128, v2, s57
  v_perm_b32 v73, v129, v2, s58
  v_perm_b32 v74, v130, v2, s59
  v_perm_b32 v75, v131, v2, s60
  buffer_store_dwordx4 v[72:75], v18, s[8:11], s68 offen sc1
  s_add_u32 s68, s68, 7168
  v_mfma_f32_16x16x32_bf16 v[140:143], a[160:163], v[60:63], 0
  v_mfma_f32_16x16x32_bf16 v[140:143], a[164:167], v[64:67], v[140:143]
  v_perm_b32 v76, v132, v2, s57
  v_perm_b32 v77, v133, v2, s58
  v_perm_b32 v78, v134, v2, s59
  v_perm_b32 v79, v135, v2, s60
  buffer_store_dwordx4 v[76:79], v18, s[8:11], s68 offen sc1
  s_add_u32 s68, s68, 7168
  v_mfma_f32_16x16x32_bf16 v[144:147], a[168:171], v[60:63], 0
  v_mfma_f32_16x16x32_bf16 v[144:147], a[172:175], v[64:67], v[144:147]
  v_perm_b32 v80, v136, v2, s57
  v_perm_b32 v81, v137, v2, s58
  v_perm_b32 v82, v138, v2, s59
  v_perm_b32 v83, v139, v2, s60
  buffer_store_dwordx4 v[80:83], v18, s[8:11], s68 offen sc1
  s_add_u32 s68, s68, 7168
  v_mfma_f32_16x16x32_bf16 v[148:151], a[176:179], v[60:63], 0
  v_mfma_f32_16x16x32_bf16 v[148:151], a[180:183], v[64:67], v[148:151]
  v_perm_b32 v84, v140, v2, s57
  v_perm_b32 v85, v141, v2, s58
  v_perm_b32 v86, v142, v2, s59
  v_perm_b32 v87, v143, v2, s60
  buffer_store_dwordx4 v[84:87], v18, s[8:11], s68 offen sc1
  s_add_u32 s68, s68, 7168
  v_mfma_f32_16x16x32_bf16 v[152:155], a[184:187], v[60:63], 0
  v_mfma_f32_16x16x32_bf16 v[152:155], a[188:191], v[64:67], v[152:155]
  v_perm_b32 v88, v144, v2, s57
  v_perm_b32 v89, v145, v2, s58
  v_perm_b32 v90, v146, v2, s59
  v_perm_b32 v91, v147, v2, s60
  buffer_store_dwordx4 v[88:91], v18, s[8:11], s68 offen sc1
  s_add_u32 s68, s68, 7168
  v_perm_b32 v92, v148, v2, s57
  v_perm_b32 v93, v149, v2, s58
  v_perm_b32 v94, v150, v2, s59
  v_perm_b32 v95, v151, v2, s60
  buffer_store_dwordx4 v[92:95], v18, s[8:11], s68 offen sc1
  s_add_u32 s68, s68, 7168
  v_perm_b32 v96, v152, v2, s57
  v_perm_b32 v97, v153, v2, s58
  v_perm_b32 v98, v154, v2, s59
  v_perm_b32 v99, v155, v2, s60
  buffer_store_dwordx4 v[96:99], v18, s[8:11], s68 offen sc1
  s_mov_b64 exec, -1
  s_branch L_exit
L_roleQ:
  s_mov_b32 s12, s22
  s_mov_b32 s13, s23
  s_mov_b32 s14, 4194304
  s_mov_b32 s15, 0x20000
  s_mov_b32 s44, s16
  s_mov_b32 s45, s17
  s_mov_b32 s46, 4096
  s_mov_b32 s47, 0x20000
  s_mov_b32 s48, s24
  s_mov_b32 s49, s25
  s_mov_b32 s50, 4194304
  s_mov_b32 s51, 0x20000
  s_lshl_b32 s7, s3, 10
  v_lshl_add_u32 v8, v1, 3, s7
  buffer_load_dwordx2 v[28:29], v8, s[44:47], 0 offen
  buffer_load_dwordx2 v[30:31], v8, s[44:47], 0 offen offset:512
  v_lshrrev_b32 v14, 3, v1
  s_mov_b32 s7, 8192
  v_mul_lo_u32 v14, v14, s7
  v_bfe_u32 v8, v1, 1, 2
  v_bfe_u32 v9, v1, 4, 2
  v_xor_b32 v8, v8, v9
  v_lshl_add_u32 v14, v8, 5, v14
  v_and_b32 v8, 1, v1
  v_lshl_add_u32 v14, v8, 4, v14
  s_sub_u32 s70, s5, 16
  s_lshl_b32 s69, s4, 10
  s_lshl_b32 s7, s70, 7
  s_add_u32 s69, s69, s7
  s_mul_i32 s68, s3, 262144
  s_add_u32 s68, s68, s69
  s_lshl_b32 s7, s3, 12
  s_add_u32 s7, s7, 0
  s_mov_b32 m0, s7
  s_nop 0
  buffer_load_dwordx4 v14, s[12:15], s68 offen nt lds
  s_add_u32 m0, m0, 1024
  s_add_u32 s68, s68, 65536
  buffer_load_dwordx4 v14, s[12:15], s68 offen nt lds
  s_add_u32 m0, m0, 1024
  s_add_u32 s68, s68, 65536
  buffer_load_dwordx4 v14, s[12:15], s68 offen nt lds
  s_add_u32 m0, m0, 1024
  s_add_u32 s68, s68, 65536
  buffer_load_dwordx4 v14, s[12:15], s68 offen nt lds
  s_add_u32 m0, m0, 13312
  s_add_u32 s68, s68, 851968
  buffer_load_dwordx4 v14, s[12:15], s68 offen nt lds
  s_add_u32 m0, m0, 1024
  s_add_u32 s68, s68, 65536
  buffer_load_dwordx4 v14, s[12:15], s68 offen nt lds
  s_add_u32 m0, m0, 1024
  s_add_u32 s68, s68, 65536
  buffer_load_dwordx4 v14, s[12:15], s68 offen nt lds
  s_add_u32 m0, m0, 1024
  s_add_u32 s68, s68, 65536
  buffer_load_dwordx4 v14, s[12:15], s68 offen nt lds
  s_add_u32 m0, m0, 13312
  s_add_u32 s68, s68, 851968
  buffer_load_dwordx4 v14, s[12:15], s68 offen nt lds
  s_add_u32 m0, m0, 1024
  s_add_u32 s68, s68, 65536
  buffer_load_dwordx4 v14, s[12:15], s68 offen nt lds
  s_add_u32 m0, m0, 1024
  s_add_u32 s68, s68, 65536
  buffer_load_dwordx4 v14, s[12:15], s68 offen nt lds
  s_add_u32 m0, m0, 1024
  s_add_u32 s68, s68, 65536
  buffer_load_dwordx4 v14, s[12:15], s68 offen nt lds
  s_add_u32 m0, m0, 13312
  s_add_u32 s68, s68, 851968
  buffer_load_dwordx4 v14, s[12:15], s68 offen nt lds
  s_add_u32 m0, m0, 1024
  s_add_u32 s68, s68, 65536
  buffer_load_dwordx4 v14, s[12:15], s68 offen nt lds
  s_add_u32 m0, m0, 1024
  s_add_u32 s68, s68, 65536
  buffer_load_dwordx4 v14, s[12:15], s68 offen nt lds
  s_add_u32 m0, m0, 1024
  s_add_u32 s68, s68, 65536
  buffer_load_dwordx4 v14, s[12:15], s68 offen nt lds
  buffer_load_dword v2, v6, s[52:55], 0 offen sc1
  v_lshrrev_b32 v8, 5, v1
  v_bfe_u32 v9, v1, 1, 4
  v_xor_b32 v9, v9, v8
  v_lshlrev_b32 v9, 5, v9
  v_lshl_add_u32 v9, v8, 10, v9
  v_and_b32 v8, 1, v1
  v_lshl_add_u32 v72, v8, 4, v9
  v_xor_b32 v73, 64, v72
  v_xor_b32 v74, 128, v72
  v_xor_b32 v75, 192, v72
  s_lshr_b32 s73, s70, 1
  s_lshl_b32 s7, s4, 2
  s_add_u32 s73, s73, s7
  s_lshl_b32 s78, s73, 17
  s_and_b32 s7, s70, 1
  s_lshl_b32 s7, s7, 9
  s_add_u32 s78, s78, s7
  s_lshl_b32 s7, s3, 13
  s_add_u32 s78, s78, s7
  s_lshl_b32 s7, s3, 12
  s_add_u32 s79, s7, 65536
  v_and_b32 v13, 3, v1
  v_lshlrev_b32 v13, 6, v13
  v_lshrrev_b32 v8, 4, v1
  v_lshl_add_u32 v13, v8, 4, v13
  v_add_u32 v13, 131072, v13
  v_lshrrev_b32 v15, 2, v1
  v_lshlrev_b32 v15, 7, v15
  v_bfe_u32 v8, v1, 3, 2
  v_xor_b32 v8, s3, v8
  v_lshl_add_u32 v15, v8, 5, v15
  v_and_b32 v8, 3, v1
  v_lshl_add_u32 v15, v8, 3, v15
  s_lshl_b32 s7, s3, 11
  v_lshl_add_u32 v16, v1, 4, s7
  s_waitcnt vmcnt(17)
  v_lshlrev_b32 v20, 16, v28
  v_and_b32 v21, 0xffff0000, v28
  v_lshlrev_b32 v22, 16, v29
  v_and_b32 v23, 0xffff0000, v29
  v_lshlrev_b32 v24, 16, v30
  v_and_b32 v25, 0xffff0000, v30
  v_lshlrev_b32 v26, 16, v31
  v_and_b32 v27, 0xffff0000, v31
  v_pk_mul_f32 v[8:9], v[20:21], v[20:21]
  v_pk_add_f32 v[10:11], v[20:21], v[22:23]
  v_pk_fma_f32 v[8:9], v[22:23], v[22:23], v[8:9]
  v_pk_add_f32 v[10:11], v[10:11], v[24:25]
  v_pk_fma_f32 v[8:9], v[24:25], v[24:25], v[8:9]
  v_pk_add_f32 v[10:11], v[10:11], v[26:27]
  v_pk_fma_f32 v[8:9], v[26:27], v[26:27], v[8:9]
  v_add_f32 v10, v10, v11
  v_add_f32 v11, v8, v9
  s_nop 0
  v_add_f32_dpp v10, v10, v10 quad_perm:[1,0,3,2] row_mask:0xf bank_mask:0xf
  v_add_f32_dpp v11, v11, v11 quad_perm:[1,0,3,2] row_mask:0xf bank_mask:0xf
  s_nop 0
  v_add_f32_dpp v10, v10, v10 quad_perm:[2,3,0,1] row_mask:0xf bank_mask:0xf
  v_add_f32_dpp v11, v11, v11 quad_perm:[2,3,0,1] row_mask:0xf bank_mask:0xf
  s_nop 0
  v_add_f32_dpp v10, v10, v10 row_half_mirror row_mask:0xf bank_mask:0xf
  v_add_f32_dpp v11, v11, v11 row_half_mirror row_mask:0xf bank_mask:0xf
  s_nop 0
  v_add_f32_dpp v10, v10, v10 row_mirror row_mask:0xf bank_mask:0xf
  v_add_f32_dpp v11, v11, v11 row_mirror row_mask:0xf bank_mask:0xf
  s_nop 1
  v_permlane16_swap_b32 v10, v11
  v_add_f32 v10, v10, v11
  v_mov_b32 v11, v10
  s_nop 1
  v_permlane32_swap_b32 v11, v10
  v_add_f32 v10, v10, v11
  v_mov_b32 v11, v10
  s_nop 1
  v_permlane16_swap_b32 v10, v11
  v_mul_f32 v10, 0x3b000000, v10
  v_mul_f32 v11, 0x3b000000, v11
  v_fma_f32 v11, -v10, v10, v11
  v_max_f32 v11, 0, v11
  v_add_f32 v11, 0x3727c5ac, v11
  v_rsq_f32 v11, v11
  s_nop 0
  v_pk_add_f32 v[20:21], v[20:21], v[10:11] op_sel_hi:[1,0] neg_lo:[0,1] neg_hi:[0,1]
  v_pk_add_f32 v[22:23], v[22:23], v[10:11] op_sel_hi:[1,0] neg_lo:[0,1] neg_hi:[0,1]
  v_pk_add_f32 v[24:25], v[24:25], v[10:11] op_sel_hi:[1,0] neg_lo:[0,1] neg_hi:[0,1]
  v_pk_add_f32 v[26:27], v[26:27], v[10:11] op_sel_hi:[1,0] neg_lo:[0,1] neg_hi:[0,1]
  v_pk_mul_f32 v[20:21], v[20:21], v[10:11] op_sel:[0,1] op_sel_hi:[1,1]
  v_pk_mul_f32 v[22:23], v[22:23], v[10:11] op_sel:[0,1] op_sel_hi:[1,1]
  v_pk_mul_f32 v[24:25], v[24:25], v[10:11] op_sel:[0,1] op_sel_hi:[1,1]
  v_pk_mul_f32 v[26:27], v[26:27], v[10:11] op_sel:[0,1] op_sel_hi:[1,1]
  s_lshl_b32 s7, s3, 11
  s_add_u32 s7, s7, 65536
  v_lshl_add_u32 v8, v1, 4, s7
  ds_write_b128 v8, v[20:23]
  ds_write_b128 v8, v[24:27] offset:1024
  v_and_b32 v8, 3, v1
  v_lshlrev_b32 v8, 11, v8
  v_lshrrev_b32 v9, 2, v1
  v_lshl_add_u32 v8, v9, 4, v8
  s_lshl_b32 s7, s3, 9
  s_add_u32 s7, s7, 65536
  v_add_u32 v10, s7, v8
  v_lshrrev_b32 v8, 5, v1
  v_lshlrev_b32 v12, 8, v8
  v_and_b32 v8, 3, v1
  v_lshl_add_u32 v12, v8, 6, v12
  v_bfe_u32 v8, v1, 2, 2
  v_lshl_add_u32 v12, v8, 4, v12
  v_bfe_u32 v8, v1, 4, 1
  v_lshl_add_u32 v12, v8, 3, v12
  s_lshl_b32 s7, s3, 10
  s_add_u32 s7, s7, 131072
  v_add_u32 v12, s7, v12
  s_waitcnt lgkmcnt(0)
  s_barrier
  ds_read_b128 v[20:23], v10
  ds_read_b128 v[24:27], v10 offset:256
  s_waitcnt vmcnt(0) lgkmcnt(0)
  s_barrier
  s_mov_b32 s66, 0
L_non_37:
  v_readfirstlane_b32 s6, v2
  s_cmp_lg_u32 s6, 0
  s_cbranch_scc1 L_nok_38
  buffer_load_dword v2, v6, s[52:55], 0 offen sc1
  s_add_u32 s66, s66, 1
  s_cmp_lt_u32 s66, 200000
  s_cbranch_scc0 L_exit
  s_waitcnt vmcnt(0)
  s_branch L_non_37
L_nok_38:
  v_mov_b32 v2, s6
  s_and_b32 s98, s6, 0xff
  s_bfe_u32 s99, s6, 524296
  s_bfe_u32 s100, s6, 524304
  s_bfe_u32 s101, s6, 524312
  v_and_b32 v17, 15, v1
  v_mul_u32_u24 v17, 16384, v17
  v_lshrrev_b32 v8, 4, v1
  v_lshl_add_u32 v17, v8, 4, v17
  s_lshl_b32 s68, s4, 11
  s_lshl_b32 s7, s70, 8
  s_add_u32 s68, s68, s7
  s_lshl_b32 s7, s3, 6
  s_add_u32 s68, s68, s7
  s_add_u32 s68, s68, 65536
  s_mov_b32 s71, 0
  s_mov_b32 s72, 8192
  s_mov_b32 s66, 0
  buffer_load_dwordx4 v[52:55], v16, s[8:11], s71 offen sc1
  buffer_load_dwordx4 v[56:59], v16, s[8:11], s71 offen offset:1024 sc1
  buffer_load_dwordx4 v[60:63], v16, s[8:11], s72 offen sc1
  buffer_load_dwordx4 v[64:67], v16, s[8:11], s72 offen offset:1024 sc1
  ds_read_b64_tr_b16 v[140:141], v15 offset:0
  ds_read_b64_tr_b16 v[142:143], v15 offset:2048
  ds_read_b64_tr_b16 v[144:145], v15 offset:4096
  ds_read_b64_tr_b16 v[146:147], v15 offset:6144
  ds_read_b64_tr_b16 v[148:149], v15 offset:8192
  ds_read_b64_tr_b16 v[150:151], v15 offset:10240
  ds_read_b64_tr_b16 v[152:153], v15 offset:12288
  ds_read_b64_tr_b16 v[154:155], v15 offset:14336
  s_waitcnt lgkmcnt(0)
  ds_read_b64_tr_b16 v[156:157], v15 offset:16384
  ds_read_b64_tr_b16 v[158:159], v15 offset:18432
  ds_read_b64_tr_b16 v[160:161], v15 offset:20480
  ds_read_b64_tr_b16 v[162:163], v15 offset:22528
  ds_read_b64_tr_b16 v[164:165], v15 offset:24576
  ds_read_b64_tr_b16 v[166:167], v15 offset:26624
  ds_read_b64_tr_b16 v[168:169], v15 offset:28672
  ds_read_b64_tr_b16 v[170:171], v15 offset:30720
  s_waitcnt lgkmcnt(0)
  ds_read_b64_tr_b16 v[172:173], v15 offset:32768
  ds_read_b64_tr_b16 v[174:175], v15 offset:34816
  ds_read_b64_tr_b16 v[176:177], v15 offset:36864
  ds_read_b64_tr_b16 v[178:179], v15 offset:38912
  ds_read_b64_tr_b16 v[180:181], v15 offset:40960
  ds_read_b64_tr_b16 v[182:183], v15 offset:43008
  ds_read_b64_tr_b16 v[184:185], v15 offset:45056
  ds_read_b64_tr_b16 v[186:187], v15 offset:47104
  s_waitcnt lgkmcnt(0)
  ds_read_b64_tr_b16 v[188:189], v15 offset:49152
  ds_read_b64_tr_b16 v[190:191], v15 offset:51200
  ds_read_b64_tr_b16 v[192:193], v15 offset:53248
  ds_read_b64_tr_b16 v[194:195], v15 offset:55296
  ds_read_b64_tr_b16 v[196:197], v15 offset:57344
  ds_read_b64_tr_b16 v[198:199], v15 offset:59392
  ds_read_b64_tr_b16 v[200:201], v15 offset:61440
  ds_read_b64_tr_b16 v[202:203], v15 offset:63488
  s_waitcnt vmcnt(0)
  v_xor_b32 v52, s98, v52
  v_xor_b32 v53, s99, v53
  v_xor_b32 v54, s100, v54
  v_xor_b32 v55, s101, v55
  v_xor_b32 v56, s98, v56
  v_xor_b32 v57, s99, v57
  v_xor_b32 v58, s100, v58
  v_xor_b32 v59, s101, v59
  v_xor_b32 v60, s98, v60
  v_xor_b32 v61, s99, v61
  v_xor_b32 v62, s100, v62
  v_xor_b32 v63, s101, v63
  v_xor_b32 v64, s98, v64
  v_xor_b32 v65, s99, v65
  v_xor_b32 v66, s100, v66
  v_xor_b32 v67, s101, v67
  v_or3_b32 v8, v52, v53, v54
  v_or3_b32 v8, v8, v55, v56
  v_or3_b32 v8, v8, v57, v58
  v_or3_b32 v8, v8, v59, v60
  v_or3_b32 v8, v8, v61, v62
  v_or3_b32 v8, v8, v63, v64
  v_or3_b32 v8, v8, v65, v66
  v_or_b32 v8, v8, v67
  v_cmp_ne_u32_sdwa vcc, v8, v6 src0_sel:BYTE_0 src1_sel:DWORD
  s_cbranch_vccz L_ok_40
  s_mov_b32 s62, 15
L_poll_39:
  s_bitcmp1_b32 s62, 0
  s_cbranch_scc0 L_sk_41
  buffer_load_dwordx4 v[52:55], v16, s[8:11], s71 offen sc1
L_sk_41:
  s_bitcmp1_b32 s62, 1
  s_cbranch_scc0 L_sk_42
  buffer_load_dwordx4 v[56:59], v16, s[8:11], s71 offen offset:1024 sc1
L_sk_42:
  s_bitcmp1_b32 s62, 2
  s_cbranch_scc0 L_sk_43
  buffer_load_dwordx4 v[60:63], v16, s[8:11], s72 offen sc1
L_sk_43:
  s_bitcmp1_b32 s62, 3
  s_cbranch_scc0 L_sk_44
  buffer_load_dwordx4 v[64:67], v16, s[8:11], s72 offen offset:1024 sc1
L_sk_44:
  s_waitcnt vmcnt(0)
  s_bitcmp1_b32 s62, 0
  s_cbranch_scc0 L_sk_45
  v_xor_b32 v52, s98, v52
  v_xor_b32 v53, s99, v53
  v_xor_b32 v54, s100, v54
  v_xor_b32 v55, s101, v55
  v_or3_b32 v8, v52, v53, v54
  v_or_b32 v8, v8, v55
  v_cmp_ne_u32_sdwa vcc, v8, v6 src0_sel:BYTE_0 src1_sel:DWORD
  s_cbranch_vccnz L_sk_45
  s_bitset0_b32 s62, 0
L_sk_45:
  s_bitcmp1_b32 s62, 1
  s_cbranch_scc0 L_sk_46
  v_xor_b32 v56, s98, v56
  v_xor_b32 v57, s99, v57
  v_xor_b32 v58, s100, v58
  v_xor_b32 v59, s101, v59
  v_or3_b32 v8, v56, v57, v58
  v_or_b32 v8, v8, v59
  v_cmp_ne_u32_sdwa vcc, v8, v6 src0_sel:BYTE_0 src1_sel:DWORD
  s_cbranch_vccnz L_sk_46
  s_bitset0_b32 s62, 1
L_sk_46:
  s_bitcmp1_b32 s62, 2
  s_cbranch_scc0 L_sk_47
  v_xor_b32 v60, s98, v60
  v_xor_b32 v61, s99, v61
  v_xor_b32 v62, s100, v62
  v_xor_b32 v63, s101, v63
  v_or3_b32 v8, v60, v61, v62
  v_or_b32 v8, v8, v63
  v_cmp_ne_u32_sdwa vcc, v8, v6 src0_sel:BYTE_0 src1_sel:DWORD
  s_cbranch_vccnz L_sk_47
  s_bitset0_b32 s62, 2
L_sk_47:
  s_bitcmp1_b32 s62, 3
  s_cbranch_scc0 L_sk_48
  v_xor_b32 v64, s98, v64
  v_xor_b32 v65, s99, v65
  v_xor_b32 v66, s100, v66
  v_xor_b32 v67, s101, v67
  v_or3_b32 v8, v64, v65, v66
  v_or_b32 v8, v8, v67
  v_cmp_ne_u32_sdwa vcc, v8, v6 src0_sel:BYTE_0 src1_sel:DWORD
  s_cbranch_vccnz L_sk_48
  s_bitset0_b32 s62, 3
L_sk_48:
  s_cmp_eq_u32 s62, 0
  s_cbranch_scc1 L_ok_40
  s_add_u32 s66, s66, 1
  s_cmp_lt_u32 s66, 200000
  s_cbranch_scc1 L_poll_39
  s_branch L_exit
L_ok_40:
  v_add_f32 v52, v52, v20
  v_add_f32 v53, v53, v21
  v_add_f32 v54, v54, v22
  v_add_f32 v55, v55, v23
  v_add_f32 v56, v56, v24
  v_add_f32 v57, v57, v25
  v_add_f32 v58, v58, v26
  v_add_f32 v59, v59, v27
  v_fmac_f32 v52, v20, v60
  v_fmac_f32 v53, v21, v61
  v_fmac_f32 v54, v22, v62
  v_fmac_f32 v55, v23, v63
  v_fmac_f32 v56, v24, v64
  v_fmac_f32 v57, v25, v65
  v_fmac_f32 v58, v26, v66
  v_fmac_f32 v59, v27, v67
  v_cvt_pk_bf16_f32 v32, v52, v53
  v_cvt_pk_bf16_f32 v33, v54, v55
  v_cvt_pk_bf16_f32 v34, v56, v57
  v_cvt_pk_bf16_f32 v35, v58, v59
  ds_write_b64 v12, v[32:33]
  ds_write_b64 v12, v[34:35] offset:512
  s_waitcnt lgkmcnt(0)
  s_barrier
  ds_read_b128 v[76:79], v13 offset:0
  ds_read_b128 v[80:83], v13 offset:256
  ds_read_b128 v[84:87], v13 offset:512
  ds_read_b128 v[88:91], v13 offset:768
  ds_read_b128 v[92:95], v13 offset:1024
  ds_read_b128 v[96:99], v13 offset:1280
  ds_read_b128 v[100:103], v13 offset:1536
  ds_read_b128 v[104:107], v13 offset:1792
  s_waitcnt lgkmcnt(7)
  v_mfma_f32_16x16x32_bf16 v[36:39], v[140:143], v[76:79], 0
  ds_read_b128 v[108:111], v13 offset:2048
  s_waitcnt lgkmcnt(7)
  v_mfma_f32_16x16x32_bf16 v[36:39], v[144:147], v[80:83], v[36:39]
  ds_read_b128 v[112:115], v13 offset:2304
  s_waitcnt lgkmcnt(7)
  v_mfma_f32_16x16x32_bf16 v[36:39], v[148:151], v[84:87], v[36:39]
  ds_read_b128 v[116:119], v13 offset:2560
  s_waitcnt lgkmcnt(7)
  v_mfma_f32_16x16x32_bf16 v[36:39], v[152:155], v[88:91], v[36:39]
  ds_read_b128 v[120:123], v13 offset:2816
  s_waitcnt lgkmcnt(7)
  v_mfma_f32_16x16x32_bf16 v[36:39], v[156:159], v[92:95], v[36:39]
  ds_read_b128 v[124:127], v13 offset:3072
  s_waitcnt lgkmcnt(7)
  v_mfma_f32_16x16x32_bf16 v[36:39], v[160:163], v[96:99], v[36:39]
  ds_read_b128 v[128:131], v13 offset:3328
  s_waitcnt lgkmcnt(7)
  v_mfma_f32_16x16x32_bf16 v[36:39], v[164:167], v[100:103], v[36:39]
  ds_read_b128 v[132:135], v13 offset:3584
  s_waitcnt lgkmcnt(7)
  v_mfma_f32_16x16x32_bf16 v[36:39], v[168:171], v[104:107], v[36:39]
  ds_read_b128 v[136:139], v13 offset:3840
  s_waitcnt lgkmcnt(7)
  v_mfma_f32_16x16x32_bf16 v[36:39], v[172:175], v[108:111], v[36:39]
  s_waitcnt lgkmcnt(6)
  v_mfma_f32_16x16x32_bf16 v[36:39], v[176:179], v[112:115], v[36:39]
  s_waitcnt lgkmcnt(5)
  v_mfma_f32_16x16x32_bf16 v[36:39], v[180:183], v[116:119], v[36:39]
  s_waitcnt lgkmcnt(4)
  v_mfma_f32_16x16x32_bf16 v[36:39], v[184:187], v[120:123], v[36:39]
  s_waitcnt lgkmcnt(3)
  v_mfma_f32_16x16x32_bf16 v[36:39], v[188:191], v[124:127], v[36:39]
  s_waitcnt lgkmcnt(2)
  v_mfma_f32_16x16x32_bf16 v[36:39], v[192:195], v[128:131], v[36:39]
  s_waitcnt lgkmcnt(1)
  v_mfma_f32_16x16x32_bf16 v[36:39], v[196:199], v[132:135], v[36:39]
  s_waitcnt lgkmcnt(0)
  v_mfma_f32_16x16x32_bf16 v[36:39], v[200:203], v[136:139], v[36:39]
  s_mov_b32 s7, 0x3e0293ee
  s_nop 6
  v_mul_f32 v36, s7, v36
  v_mul_f32 v37, s7, v37
  v_mul_f32 v38, s7, v38
  v_mul_f32 v39, s7, v39
  v_perm_b32 v32, v36, v2, s57
  v_perm_b32 v33, v37, v2, s58
  v_perm_b32 v34, v38, v2, s59
  v_perm_b32 v35, v39, v2, s60
  s_mov_b64 exec, s[64:65]
  s_add_u32 s7, s68, 2097152
  buffer_store_dwordx4 v[32:35], v17, s[8:11], s7 offen
  buffer_store_dwordx4 v[32:35], v17, s[8:11], s68 offen  sc1
  s_mov_b64 exec, -1
  s_add_u32 m0, s79, 0
  s_add_u32 s7, s78, 0
  buffer_load_dwordx4 v72, s[48:51], s7 offen nt lds
  s_add_u32 m0, s79, 1024
  s_add_u32 s7, s78, 2048
  buffer_load_dwordx4 v73, s[48:51], s7 offen nt lds
  s_add_u32 m0, s79, 2048
  s_add_u32 s7, s78, 4096
  buffer_load_dwordx4 v74, s[48:51], s7 offen nt lds
  s_add_u32 m0, s79, 3072
  s_add_u32 s7, s78, 6144
  buffer_load_dwordx4 v75, s[48:51], s7 offen nt lds
  s_add_u32 m0, s79, 16384
  s_add_u32 s7, s78, 32768
  buffer_load_dwordx4 v72, s[48:51], s7 offen nt lds
  s_add_u32 m0, s79, 17408
  s_add_u32 s7, s78, 34816
  buffer_load_dwordx4 v73, s[48:51], s7 offen nt lds
  s_add_u32 m0, s79, 18432
  s_add_u32 s7, s78, 36864
  buffer_load_dwordx4 v74, s[48:51], s7 offen nt lds
  s_add_u32 m0, s79, 19456
  s_add_u32 s7, s78, 38912
  buffer_load_dwordx4 v75, s[48:51], s7 offen nt lds
  s_add_u32 m0, s79, 32768
  s_add_u32 s7, s78, 65536
  buffer_load_dwordx4 v72, s[48:51], s7 offen nt lds
  s_add_u32 m0, s79, 33792
  s_add_u32 s7, s78, 67584
  buffer_load_dwordx4 v73, s[48:51], s7 offen nt lds
  s_add_u32 m0, s79, 34816
  s_add_u32 s7, s78, 69632
  buffer_load_dwordx4 v74, s[48:51], s7 offen nt lds
  s_add_u32 m0, s79, 35840
  s_add_u32 s7, s78, 71680
  buffer_load_dwordx4 v75, s[48:51], s7 offen nt lds
  s_add_u32 m0, s79, 49152
  s_add_u32 s7, s78, 98304
  buffer_load_dwordx4 v72, s[48:51], s7 offen nt lds
  s_add_u32 m0, s79, 50176
  s_add_u32 s7, s78, 100352
  buffer_load_dwordx4 v73, s[48:51], s7 offen nt lds
  s_add_u32 m0, s79, 51200
  s_add_u32 s7, s78, 102400
  buffer_load_dwordx4 v74, s[48:51], s7 offen nt lds
  s_add_u32 m0, s79, 52224
  s_add_u32 s7, s78, 104448
  buffer_load_dwordx4 v75, s[48:51], s7 offen nt lds
  v_lshrrev_b32 v15, 2, v1
  v_and_b32 v8, 7, v15
  v_lshlrev_b32 v15, 9, v15
  s_lshl_b32 s7, s3, 2
  v_xor_b32 v8, s7, v8
  v_lshl_add_u32 v15, v8, 5, v15
  v_and_b32 v8, 3, v1
  v_lshl_add_u32 v15, v8, 3, v15
  v_add_u32 v15, 65536, v15
  v_and_b32 v8, 3, v1
  v_lshlrev_b32 v16, 11, v8
  v_lshrrev_b32 v9, 2, v1
  v_lshl_add_u32 v16, v9, 4, v16
  s_lshl_b32 s74, s3, 3
  s_add_u32 s74, s74, s4
  s_lshl_b32 s75, s74, 8
  s_lshl_b32 s74, s74, 13
  s_lshr_b32 s7, s70, 1
  s_lshl_b32 s68, s7, 9
  s_add_u32 s74, s74, s68
  s_add_u32 s74, s74, 131072
  s_lshl_b32 s7, s7, 6
  s_add_u32 s75, s75, s7
  s_add_u32 s75, s75, 393216
  v_lshlrev_b32 v10, 4, v8
  v_lshrrev_b32 v8, 5, v1
  v_lshlrev_b32 v12, 8, v8
  v_bfe_u32 v8, v1, 2, 2
  v_lshl_add_u32 v12, v8, 4, v12
  v_bfe_u32 v8, v1, 4, 1
  v_lshl_add_u32 v12, v8, 3, v12
  s_lshl_b32 s7, s3, 6
  s_add_u32 s7, s7, 135168
  v_add_u32 v12, s7, v12
  v_and_b32 v13, 3, v1
  v_lshlrev_b32 v13, 6, v13
  v_lshrrev_b32 v8, 4, v1
  v_lshl_add_u32 v13, v8, 4, v13
  v_add_u32 v13, 135168, v13
  v_and_b32 v17, 15, v1
  v_mul_u32_u24 v17, 64, v17
  v_lshrrev_b32 v8, 4, v1
  v_lshl_add_u32 v17, v8, 4, v17
  v_and_b32 v8, 12, v1
  v_add_u32 v8, 12, v8
  v_and_b32 v8, 16, v8
  v_lshl_or_b32 v17, v8, 27, v17
  s_and_b32 s69, s70, 1
  s_lshl_b32 s69, s69, 2
  s_add_u32 s69, s69, s3
  s_lshl_b32 s69, s69, 15
  s_lshl_b32 s7, s73, 8
  s_add_u32 s69, s69, s7
  s_add_u32 s69, s69, 524288
  s_waitcnt vmcnt(0)
  s_barrier
  s_mov_b32 s66, 0
  s_add_u32 s76, s74, 2097152
  s_add_u32 s77, s75, 2097152
  buffer_load_dwordx4 v[52:55], v16, s[8:11], s76 offen sc1
  buffer_load_dwordx4 v[56:59], v16, s[8:11], s76 offen offset:256 sc1
  buffer_load_dwordx4 v[68:71], v10, s[8:11], s77 offen sc1
  v_xor_b32 v9, 0, v15
  ds_read_b64_tr_b16 v[140:141], v9 offset:0
  ds_read_b64_tr_b16 v[142:143], v9 offset:8192
  ds_read_b64_tr_b16 v[144:145], v9 offset:16384
  ds_read_b64_tr_b16 v[146:147], v9 offset:24576
  ds_read_b64_tr_b16 v[148:149], v9 offset:32768
  ds_read_b64_tr_b16 v[150:151], v9 offset:40960
  ds_read_b64_tr_b16 v[152:153], v9 offset:49152
  ds_read_b64_tr_b16 v[154:155], v9 offset:57344
  s_waitcnt lgkmcnt(0)
  v_xor_b32 v9, 32, v15
  ds_read_b64_tr_b16 v[156:157], v9 offset:0
  ds_read_b64_tr_b16 v[158:159], v9 offset:8192
  ds_read_b64_tr_b16 v[160:161], v9 offset:16384
  ds_read_b64_tr_b16 v[162:163], v9 offset:24576
  ds_read_b64_tr_b16 v[164:165], v9 offset:32768
  ds_read_b64_tr_b16 v[166:167], v9 offset:40960
  ds_read_b64_tr_b16 v[168:169], v9 offset:49152
  ds_read_b64_tr_b16 v[170:171], v9 offset:57344
  s_waitcnt lgkmcnt(0)
  v_xor_b32 v9, 64, v15
  ds_read_b64_tr_b16 v[172:173], v9 offset:0
  ds_read_b64_tr_b16 v[174:175], v9 offset:8192
  ds_read_b64_tr_b16 v[176:177], v9 offset:16384
  ds_read_b64_tr_b16 v[178:179], v9 offset:24576
  ds_read_b64_tr_b16 v[180:181], v9 offset:32768
  ds_read_b64_tr_b16 v[182:183], v9 offset:40960
  ds_read_b64_tr_b16 v[184:185], v9 offset:49152
  ds_read_b64_tr_b16 v[186:187], v9 offset:57344
  s_waitcnt lgkmcnt(0)
  v_xor_b32 v9, 96, v15
  ds_read_b64_tr_b16 v[188:189], v9 offset:0
  ds_read_b64_tr_b16 v[190:191], v9 offset:8192
  ds_read_b64_tr_b16 v[192:193], v9 offset:16384
  ds_read_b64_tr_b16 v[194:195], v9 offset:24576
  ds_read_b64_tr_b16 v[196:197], v9 offset:32768
  ds_read_b64_tr_b16 v[198:199], v9 offset:40960
  ds_read_b64_tr_b16 v[200:201], v9 offset:49152
  ds_read_b64_tr_b16 v[202:203], v9 offset:57344
  s_waitcnt vmcnt(0)
  v_xor_b32 v52, s98, v52
  v_xor_b32 v53, s99, v53
  v_xor_b32 v54, s100, v54
  v_xor_b32 v55, s101, v55
  v_xor_b32 v56, s98, v56
  v_xor_b32 v57, s99, v57
  v_xor_b32 v58, s100, v58
  v_xor_b32 v59, s101, v59
  v_xor_b32 v68, s98, v68
  v_xor_b32 v69, s99, v69
  v_xor_b32 v70, s100, v70
  v_xor_b32 v71, s101, v71
  v_or3_b32 v8, v52, v53, v54
  v_or3_b32 v8, v8, v55, v56
  v_or3_b32 v8, v8, v57, v58
  v_or3_b32 v8, v8, v59, v68
  v_or3_b32 v8, v8, v69, v70
  v_or_b32 v8, v8, v71
  v_cmp_ne_u32_sdwa vcc, v8, v6 src0_sel:BYTE_0 src1_sel:DWORD
  s_cbranch_vccz L_ok_50
L_poll_49:
  s_and_b32 s7, s66, 15
  s_cmp_eq_u32 s7, 15
  s_cselect_b32 s7, 0, 2097152
  s_add_u32 s76, s74, s7
  s_add_u32 s77, s75, s7
  buffer_load_dwordx4 v[52:55], v16, s[8:11], s76 offen sc1
  buffer_load_dwordx4 v[56:59], v16, s[8:11], s76 offen offset:256 sc1
  buffer_load_dwordx4 v[68:71], v10, s[8:11], s77 offen sc1
  s_waitcnt vmcnt(0)
  v_xor_b32 v52, s98, v52
  v_xor_b32 v53, s99, v53
  v_xor_b32 v54, s100, v54
  v_xor_b32 v55, s101, v55
  v_xor_b32 v56, s98, v56
  v_xor_b32 v57, s99, v57
  v_xor_b32 v58, s100, v58
  v_xor_b32 v59, s101, v59
  v_xor_b32 v68, s98, v68
  v_xor_b32 v69, s99, v69
  v_xor_b32 v70, s100, v70
  v_xor_b32 v71, s101, v71
  v_or3_b32 v8, v52, v53, v54
  v_or3_b32 v8, v8, v55, v56
  v_or3_b32 v8, v8, v57, v58
  v_or3_b32 v8, v8, v59, v68
  v_or3_b32 v8, v8, v69, v70
  v_or_b32 v8, v8, v71
  v_cmp_ne_u32_sdwa vcc, v8, v6 src0_sel:BYTE_0 src1_sel:DWORD
  s_cbranch_vccz L_ok_50
  s_add_u32 s66, s66, 1
  s_cmp_lt_u32 s66, 200000
  s_cbranch_scc1 L_poll_49
  s_branch L_exit
L_ok_50:
  v_max_f32_dpp v8, v68, v68 quad_perm:[1,0,3,2] row_mask:0xf bank_mask:0xf
  s_nop 1
  v_max_f32_dpp v8, v8, v8 quad_perm:[2,3,0,1] row_mask:0xf bank_mask:0xf
  v_sub_f32 v8, v68, v8
  v_exp_f32 v8, v8
  s_nop 0
  v_mul_f32 v9, v8, v69
  s_nop 1
  v_add_f32_dpp v9, v9, v9 quad_perm:[1,0,3,2] row_mask:0xf bank_mask:0xf
  s_nop 1
  v_add_f32_dpp v9, v9, v9 quad_perm:[2,3,0,1] row_mask:0xf bank_mask:0xf
  v_rcp_f32 v9, v9
  s_nop 0
  v_mul_f32 v8, v8, v9
  v_pk_mul_f32 v[52:53], v[52:53], v[8:9] op_sel_hi:[1,0]
  v_pk_mul_f32 v[54:55], v[54:55], v[8:9] op_sel_hi:[1,0]
  v_pk_mul_f32 v[56:57], v[56:57], v[8:9] op_sel_hi:[1,0]
  v_pk_mul_f32 v[58:59], v[58:59], v[8:9] op_sel_hi:[1,0]
  v_add_f32_dpp v52, v52, v52 quad_perm:[1,0,3,2] row_mask:0xf bank_mask:0xf
  v_add_f32_dpp v53, v53, v53 quad_perm:[1,0,3,2] row_mask:0xf bank_mask:0xf
  v_add_f32_dpp v54, v54, v54 quad_perm:[1,0,3,2] row_mask:0xf bank_mask:0xf
  v_add_f32_dpp v55, v55, v55 quad_perm:[1,0,3,2] row_mask:0xf bank_mask:0xf
  v_add_f32_dpp v56, v56, v56 quad_perm:[1,0,3,2] row_mask:0xf bank_mask:0xf
  v_add_f32_dpp v57, v57, v57 quad_perm:[1,0,3,2] row_mask:0xf bank_mask:0xf
  v_add_f32_dpp v58, v58, v58 quad_perm:[1,0,3,2] row_mask:0xf bank_mask:0xf
  v_add_f32_dpp v59, v59, v59 quad_perm:[1,0,3,2] row_mask:0xf bank_mask:0xf
  v_add_f32_dpp v52, v52, v52 quad_perm:[2,3,0,1] row_mask:0xf bank_mask:0xf
  v_add_f32_dpp v53, v53, v53 quad_perm:[2,3,0,1] row_mask:0xf bank_mask:0xf
  v_add_f32_dpp v54, v54, v54 quad_perm:[2,3,0,1] row_mask:0xf bank_mask:0xf
  v_add_f32_dpp v55, v55, v55 quad_perm:[2,3,0,1] row_mask:0xf bank_mask:0xf
  v_add_f32_dpp v56, v56, v56 quad_perm:[2,3,0,1] row_mask:0xf bank_mask:0xf
  v_add_f32_dpp v57, v57, v57 quad_perm:[2,3,0,1] row_mask:0xf bank_mask:0xf
  v_add_f32_dpp v58, v58, v58 quad_perm:[2,3,0,1] row_mask:0xf bank_mask:0xf
  v_add_f32_dpp v59, v59, v59 quad_perm:[2,3,0,1] row_mask:0xf bank_mask:0xf
  v_cvt_pk_bf16_f32 v32, v52, v53
  v_cvt_pk_bf16_f32 v33, v54, v55
  v_cvt_pk_bf16_f32 v34, v56, v57
  v_cvt_pk_bf16_f32 v35, v58, v59
  ds_write_b64 v12, v[32:33]
  ds_write_b64 v12, v[34:35] offset:512
  s_waitcnt lgkmcnt(0)
  s_barrier
  ds_read_b128 v[76:79], v13 offset:0
  ds_read_b128 v[80:83], v13 offset:256
  ds_read_b128 v[84:87], v13 offset:512
  ds_read_b128 v[88:91], v13 offset:768
  s_waitcnt lgkmcnt(3)
  v_mfma_f32_16x16x32_bf16 v[36:39], v[140:143], v[76:79], 0
  s_waitcnt lgkmcnt(2)
  v_mfma_f32_16x16x32_bf16 v[36:39], v[144:147], v[80:83], v[36:39]
  s_waitcnt lgkmcnt(1)
  v_mfma_f32_16x16x32_bf16 v[36:39], v[148:151], v[84:87], v[36:39]
  s_waitcnt lgkmcnt(0)
  v_mfma_f32_16x16x32_bf16 v[36:39], v[152:155], v[88:91], v[36:39]
  v_mfma_f32_16x16x32_bf16 v[40:43], v[156:159], v[76:79], 0
  v_mfma_f32_16x16x32_bf16 v[40:43], v[160:163], v[80:83], v[40:43]
  v_mfma_f32_16x16x32_bf16 v[40:43], v[164:167], v[84:87], v[40:43]
  v_mfma_f32_16x16x32_bf16 v[40:43], v[168:171], v[88:91], v[40:43]
  v_mfma_f32_16x16x32_bf16 v[44:47], v[172:175], v[76:79], 0
  v_mfma_f32_16x16x32_bf16 v[44:47], v[176:179], v[80:83], v[44:47]
  v_mfma_f32_16x16x32_bf16 v[44:47], v[180:183], v[84:87], v[44:47]
  v_mfma_f32_16x16x32_bf16 v[44:47], v[184:187], v[88:91], v[44:47]
  v_perm_b32 v92, v36, v2, s57
  v_perm_b32 v93, v37, v2, s58
  v_perm_b32 v94, v38, v2, s59
  v_perm_b32 v95, v39, v2, s60
  buffer_store_dwordx4 v[92:95], v17, s[8:11], s69 offen sc1
  s_add_u32 s69, s69, 8192
  v_mfma_f32_16x16x32_bf16 v[48:51], v[188:191], v[76:79], 0
  v_mfma_f32_16x16x32_bf16 v[48:51], v[192:195], v[80:83], v[48:51]
  v_mfma_f32_16x16x32_bf16 v[48:51], v[196:199], v[84:87], v[48:51]
  v_mfma_f32_16x16x32_bf16 v[48:51], v[200:203], v[88:91], v[48:51]
  v_perm_b32 v96, v40, v2, s57
  v_perm_b32 v97, v41, v2, s58
  v_perm_b32 v98, v42, v2, s59
  v_perm_b32 v99, v43, v2, s60
  buffer_store_dwordx4 v[96:99], v17, s[8:11], s69 offen sc1
  s_add_u32 s69, s69, 8192
  v_perm_b32 v100, v44, v2, s57
  v_perm_b32 v101, v45, v2, s58
  v_perm_b32 v102, v46, v2, s59
  v_perm_b32 v103, v47, v2, s60
  buffer_store_dwordx4 v[100:103], v17, s[8:11], s69 offen sc1
  s_add_u32 s69, s69, 8192
  v_perm_b32 v104, v48, v2, s57
  v_perm_b32 v105, v49, v2, s58
  v_perm_b32 v106, v50, v2, s59
  v_perm_b32 v107, v51, v2, s60
  buffer_store_dwordx4 v[104:107], v17, s[8:11], s69 offen sc1
  s_mov_b64 exec, -1
  s_branch L_exit
L_roleA:
  s_mov_b32 s12, s18
  s_mov_b32 s13, s19
  s_mov_b32 s14, 33554432
  s_mov_b32 s15, 0x20000
  s_mov_b32 s44, s20
  s_mov_b32 s45, s21
  s_mov_b32 s46, 33554432
  s_mov_b32 s47, 0x20000
  s_lshr_b32 s69, s5, 2
  s_and_b32 s70, s5, 3
  s_lshl_b32 s71, s69, 3
  s_add_u32 s71, s71, s4
  s_lshl_b32 s71, s71, 20
  s_lshl_b32 s7, s70, 16
  s_add_u32 s71, s71, s7
  s_add_u32 s71, s71, 786432
  v_lshrrev_b32 v8, 4, v1
  v_and_b32 v9, 15, v1
  v_xor_b32 v9, v9, v8
  v_lshlrev_b32 v9, 4, v9
  v_lshl_add_u32 v12, v8, 8, v9
  v_xor_b32 v13, 64, v12
  v_xor_b32 v14, 128, v12
  v_xor_b32 v15, 192, v12
  s_lshl_b32 s7, s3, 14
  s_add_u32 s68, s71, s7
  s_mov_b32 m0, s7
  s_nop 0
  buffer_load_dwordx4 v12, s[12:15], s68 offen offset:0 nt lds
  buffer_load_dwordx4 v13, s[12:15], s68 offen offset:1024 nt lds
  buffer_load_dwordx4 v14, s[12:15], s68 offen offset:2048 nt lds
  buffer_load_dwordx4 v15, s[12:15], s68 offen offset:3072 nt lds
  s_mov_b32 s75, s68
  v_lshrrev_b32 v8, 4, v1
  v_bfe_u32 v9, v1, 1, 3
  v_xor_b32 v9, v9, v8
  v_lshlrev_b32 v9, 5, v9
  v_lshl_add_u32 v9, v8, 8, v9
  v_and_b32 v8, 1, v1
  v_lshl_add_u32 v16, v8, 4, v9
  v_xor_b32 v17, 128, v16
  v_and_b32 v8, 15, v1
  v_lshrrev_b32 v9, 4, v1
  v_xor_b32 v9, v9, v8
  v_lshlrev_b32 v9, 4, v9
  v_lshl_add_u32 v9, v8, 8, v9
  s_lshl_b32 s7, s3, 14
  v_add_u32 v18, s7, v9
  v_xor_b32 v19, 64, v18
  v_xor_b32 v20, 128, v18
  v_xor_b32 v21, 192, v18
  s_lshl_b32 s72, s69, 3
  s_add_u32 s72, s72, s4
  s_lshl_b32 s72, s72, 11
  s_lshl_b32 s7, s3, 9
  s_add_u32 s72, s72, s7
  s_add_u32 s72, s72, 65536
  v_and_b32 v24, 31, v1
  v_lshlrev_b32 v24, 4, v24
  v_bfe_u32 v8, v1, 3, 2
  v_lshlrev_b32 v25, 8, v8
  v_bfe_u32 v8, v1, 1, 2
  v_lshl_add_u32 v25, v8, 4, v25
  v_and_b32 v8, 1, v1
  v_lshl_add_u32 v25, v8, 3, v25
  s_lshl_b32 s7, s3, 6
  s_add_u32 s7, s7, 131072
  v_add_u32 v25, s7, v25
  v_and_b32 v26, 3, v1
  v_lshlrev_b32 v26, 6, v26
  v_lshrrev_b32 v8, 4, v1
  v_lshl_add_u32 v26, v8, 4, v26
  v_add_u32 v26, 0, v26
  v_add_u32 v28, 135168, v26
  v_add_u32 v26, 131072, v26
  s_lshl_b32 s7, s3, 9
  v_add_u32 v27, s7, v28
  v_and_b32 v31, 3, v1
  v_lshlrev_b32 v31, 5, v31
  v_add_u32 v31, 137216, v31
  s_lshl_b32 s7, s3, 3
  v_add_u32 v30, s7, v31
  v_lshrrev_b32 v8, 2, v1
  v_and_b32 v9, 7, v8
  s_lshl_b32 s7, s3, 1
  v_xor_b32 v9, s7, v9
  v_lshlrev_b32 v9, 5, v9
  v_lshl_add_u32 v9, v8, 8, v9
  v_and_b32 v8, 3, v1
  v_lshl_add_u32 v9, v8, 3, v9
  v_add_u32 v22, 65536, v9
  v_xor_b32 v23, 32, v22
  v_and_b32 v29, 15, v1
  v_mul_u32_u24 v29, 512, v29
  v_lshrrev_b32 v8, 4, v1
  v_lshl_add_u32 v29, v8, 4, v29
  s_lshl_b32 s73, s69, 3
  s_add_u32 s73, s73, s4
  s_lshl_b32 s74, s73, 8
  s_lshl_b32 s73, s73, 2
  s_add_u32 s73, s73, s70
  s_lshl_b32 s73, s73, 11
  s_lshl_b32 s7, s3, 7
  s_add_u32 s73, s73, s7
  s_add_u32 s73, s73, 131072
  s_lshl_b32 s7, s70, 4
  s_add_u32 s74, s74, s7
  s_add_u32 s74, s74, 393216
  v_and_b32 v32, 15, v1
  v_lshlrev_b32 v32, 6, v32
  v_bfe_u32 v8, v1, 2, 2
  v_and_b32 v9, 3, v1
  v_bfe_u32 v10, v1, 4, 1
  v_lshl_add_u32 v9, v10, 2, v9
  s_lshl_b32 s7, s5, 3
  v_add_u32 v9, s7, v9
  v_lshlrev_b32 v168, 10, v8
  v_lshl_add_u32 v168, v9, 3, v168
  v_lshlrev_b32 v169, 11, v8
  v_lshl_add_u32 v169, v9, 4, v169
  v_lshlrev_b32 v176, 4, v8
  v_lshl_add_u32 v176, v9, 6, v176
  v_lshlrev_b32 v170, 4, v1
  v_lshrrev_b32 v177, 2, v1
  v_lshlrev_b32 v177, 7, v177
  v_and_b32 v11, 3, v1
  v_lshl_add_u32 v177, v11, 4, v177
  v_and_b32 v8, 15, v1
  v_lshlrev_b32 v8, 4, v8
  v_add_u32 v8, 137472, v8
  v_lshrrev_b32 v9, 4, v1
  v_lshl_add_u32 v171, v9, 2, v8
  s_lshl_b32 s7, s3, 8
  v_add_u32 v171, s7, v171
  v_lshl_add_u32 v172, v10, 9, v8
  v_and_b32 v8, 31, v1
  v_lshlrev_b32 v173, 4, v8
  v_add_u32 v173, 138496, v173
  v_and_b32 v8, 3, v1
  v_lshlrev_b32 v174, 6, v8
  v_lshrrev_b32 v9, 4, v1
  v_lshl_add_u32 v174, v9, 2, v174
  s_lshr_b32 s7, s4, 2
  s_lshl_b32 s7, s7, 8
  s_and_b32 s68, s4, 3
  s_lshl_b32 s68, s68, 4
  s_add_u32 s7, s7, s68
  s_add_u32 s7, s7, 138496
  v_add_u32 v174, s7, v174
  v_lshlrev_b32 v175, 10, v8
  v_lshl_add_u32 v175, v9, 1, v175
  s_lshl_b32 s7, s5, 3
  s_add_u32 s7, s7, s4
  s_lshl_b32 s7, s7, 3
  v_add_u32 v175, s7, v175
  s_mov_b32 s68, s75
  s_waitcnt vmcnt(0)
  s_add_u32 m0, m0, 4096
  s_add_u32 s68, s68, 4096
  buffer_load_dwordx4 v12, s[12:15], s68 offen offset:0 nt lds
  buffer_load_dwordx4 v13, s[12:15], s68 offen offset:1024 nt lds
  buffer_load_dwordx4 v14, s[12:15], s68 offen offset:2048 nt lds
  buffer_load_dwordx4 v15, s[12:15], s68 offen offset:3072 nt lds
  s_waitcnt vmcnt(0)
  s_add_u32 m0, m0, 4096
  s_add_u32 s68, s68, 4096
  buffer_load_dwordx4 v12, s[12:15], s68 offen offset:0 nt lds
  buffer_load_dwordx4 v13, s[12:15], s68 offen offset:1024 nt lds
  buffer_load_dwordx4 v14, s[12:15], s68 offen offset:2048 nt lds
  buffer_load_dwordx4 v15, s[12:15], s68 offen offset:3072 nt lds
  s_add_u32 m0, m0, 4096
  s_add_u32 s68, s68, 4096
  buffer_load_dwordx4 v12, s[12:15], s68 offen offset:0 nt lds
  buffer_load_dwordx4 v13, s[12:15], s68 offen offset:1024 nt lds
  buffer_load_dwordx4 v14, s[12:15], s68 offen offset:2048 nt lds
  buffer_load_dwordx4 v15, s[12:15], s68 offen offset:3072 nt lds
  s_lshl_b32 s7, s3, 12
  s_add_u32 s68, s71, s7
  s_add_u32 s7, s7, 65536
  s_mov_b32 m0, s7
  s_nop 0
  buffer_load_dwordx4 v16, s[44:47], s68 offen offset:0 nt lds
  buffer_load_dwordx4 v17, s[44:47], s68 offen offset:1024 nt lds
  buffer_load_dwordx4 v16, s[44:47], s68 offen offset:2048 nt lds
  buffer_load_dwordx4 v17, s[44:47], s68 offen offset:3072 nt lds
  s_add_u32 m0, m0, 16384
  s_add_u32 s68, s68, 16384
  s_nop 0
  buffer_load_dwordx4 v16, s[44:47], s68 offen offset:0 nt lds
  buffer_load_dwordx4 v17, s[44:47], s68 offen offset:1024 nt lds
  buffer_load_dwordx4 v16, s[44:47], s68 offen offset:2048 nt lds
  buffer_load_dwordx4 v17, s[44:47], s68 offen offset:3072 nt lds
  s_add_u32 m0, m0, 16384
  s_add_u32 s68, s68, 16384
  s_nop 0
  buffer_load_dwordx4 v16, s[44:47], s68 offen offset:0 nt lds
  buffer_load_dwordx4 v17, s[44:47], s68 offen offset:1024 nt lds
  buffer_load_dwordx4 v16, s[44:47], s68 offen offset:2048 nt lds
  buffer_load_dwordx4 v17, s[44:47], s68 offen offset:3072 nt lds
  s_add_u32 m0, m0, 16384
  s_add_u32 s68, s68, 16384
  s_nop 0
  buffer_load_dwordx4 v16, s[44:47], s68 offen offset:0 nt lds
  buffer_load_dwordx4 v17, s[44:47], s68 offen offset:1024 nt lds
  buffer_load_dwordx4 v16, s[44:47], s68 offen offset:2048 nt lds
  buffer_load_dwordx4 v17, s[44:47], s68 offen offset:3072 nt lds
  buffer_load_dword v2, v6, s[52:55], 0 offen sc1
  s_waitcnt vmcnt(17)
  ds_read_b128 v[80:83], v18 offset:0
  ds_read_b128 v[84:87], v19 offset:0
  ds_read_b128 v[88:91], v20 offset:0
  ds_read_b128 v[92:95], v21 offset:0
  ds_read_b128 v[96:99], v18 offset:4096
  ds_read_b128 v[100:103], v19 offset:4096
  ds_read_b128 v[104:107], v20 offset:4096
  ds_read_b128 v[108:111], v21 offset:4096
  s_waitcnt lgkmcnt(0)
  ds_read_b128 v[112:115], v18 offset:8192
  ds_read_b128 v[116:119], v19 offset:8192
  ds_read_b128 v[120:123], v20 offset:8192
  ds_read_b128 v[124:127], v21 offset:8192
  ds_read_b128 v[128:131], v18 offset:12288
  ds_read_b128 v[132:135], v19 offset:12288
  ds_read_b128 v[136:139], v20 offset:12288
  ds_read_b128 v[140:143], v21 offset:12288
  s_waitcnt lgkmcnt(0)
  s_waitcnt vmcnt(0)
  s_mov_b32 s66, 0
L_non_51:
  v_readfirstlane_b32 s6, v2
  s_cmp_lg_u32 s6, 0
  s_cbranch_scc1 L_nok_52
  buffer_load_dword v2, v6, s[52:55], 0 offen sc1
  s_add_u32 s66, s66, 1
  s_cmp_lt_u32 s66, 200000
  s_cbranch_scc0 L_exit
  s_waitcnt vmcnt(0)
  s_branch L_non_51
L_nok_52:
  v_mov_b32 v2, s6
  s_and_b32 s98, s6, 0xff
  s_bfe_u32 s99, s6, 524296
  s_bfe_u32 s100, s6, 524304
  s_bfe_u32 s101, s6, 524312
  s_mov_b32 s66, 0
L_poll_53:
  s_and_b32 s7, s66, 15
  s_cmp_eq_u32 s7, 15
  s_cselect_b32 s7, 0, 2097152
  s_add_u32 s76, s72, s7
  buffer_load_dwordx4 v[36:39], v24, s[8:11], s76 offen sc1
  s_waitcnt vmcnt(0)
  v_xor_b32 v36, s98, v36
  v_xor_b32 v37, s99, v37
  v_xor_b32 v38, s100, v38
  v_xor_b32 v39, s101, v39
  v_or3_b32 v8, v36, v37, v38
  v_or_b32 v8, v8, v39
  v_cmp_ne_u32_sdwa vcc, v8, v6 src0_sel:BYTE_0 src1_sel:DWORD
  s_cbranch_vccz L_ok_54
  s_add_u32 s66, s66, 1
  s_cmp_lt_u32 s66, 200000
  s_cbranch_scc1 L_poll_53
  s_branch L_exit
L_ok_54:
  v_cvt_pk_bf16_f32 v56, v36, v37
  v_cvt_pk_bf16_f32 v57, v38, v39
  ds_write_b64 v25, v[56:57]
  s_waitcnt lgkmcnt(0)
  s_barrier
  ds_read_b128 v[40:43], v26 offset:0
  ds_read_b128 v[44:47], v26 offset:256
  ds_read_b128 v[48:51], v26 offset:512
  ds_read_b128 v[52:55], v26 offset:768
  ds_read_b64_tr_b16 a[0:1], v22 offset:0
  ds_read_b64_tr_b16 a[2:3], v22 offset:4096
  ds_read_b64_tr_b16 a[4:5], v23 offset:0
  ds_read_b64_tr_b16 a[6:7], v23 offset:4096
  ds_read_b64_tr_b16 a[8:9], v22 offset:8192
  ds_read_b64_tr_b16 a[10:11], v22 offset:12288
  ds_read_b64_tr_b16 a[12:13], v23 offset:8192
  ds_read_b64_tr_b16 a[14:15], v23 offset:12288
  s_waitcnt lgkmcnt(8)
  v_mfma_f32_16x16x32_bf16 v[64:67], v[80:83], v[40:43], 0
  v_mfma_f32_16x16x32_bf16 v[68:71], v[96:99], v[40:43], 0
  v_mfma_f32_16x16x32_bf16 v[72:75], v[112:115], v[40:43], 0
  v_mfma_f32_16x16x32_bf16 v[76:79], v[128:131], v[40:43], 0
  s_waitcnt lgkmcnt(4)
  ds_read_b64_tr_b16 a[16:17], v22 offset:16384
  ds_read_b64_tr_b16 a[18:19], v22 offset:20480
  ds_read_b64_tr_b16 a[20:21], v23 offset:16384
  ds_read_b64_tr_b16 a[22:23], v23 offset:20480
  s_waitcnt lgkmcnt(8)
  ds_read_b64_tr_b16 a[24:25], v22 offset:24576
  ds_read_b64_tr_b16 a[26:27], v22 offset:28672
  ds_read_b64_tr_b16 a[28:29], v23 offset:24576
  ds_read_b64_tr_b16 a[30:31], v23 offset:28672
  v_mfma_f32_16x16x32_bf16 v[64:67], v[84:87], v[44:47], v[64:67]
  v_mfma_f32_16x16x32_bf16 v[68:71], v[100:103], v[44:47], v[68:71]
  v_mfma_f32_16x16x32_bf16 v[72:75], v[116:119], v[44:47], v[72:75]
  v_mfma_f32_16x16x32_bf16 v[76:79], v[132:135], v[44:47], v[76:79]
  s_waitcnt lgkmcnt(4)
  ds_read_b64_tr_b16 a[32:33], v22 offset:32768
  ds_read_b64_tr_b16 a[34:35], v22 offset:36864
  ds_read_b64_tr_b16 a[36:37], v23 offset:32768
  ds_read_b64_tr_b16 a[38:39], v23 offset:36864
  s_waitcnt lgkmcnt(8)
  ds_read_b64_tr_b16 a[40:41], v22 offset:40960
  ds_read_b64_tr_b16 a[42:43], v22 offset:45056
  ds_read_b64_tr_b16 a[44:45], v23 offset:40960
  ds_read_b64_tr_b16 a[46:47], v23 offset:45056
  v_mfma_f32_16x16x32_bf16 v[64:67], v[88:91], v[48:51], v[64:67]
  v_mfma_f32_16x16x32_bf16 v[68:71], v[104:107], v[48:51], v[68:71]
  v_mfma_f32_16x16x32_bf16 v[72:75], v[120:123], v[48:51], v[72:75]
  v_mfma_f32_16x16x32_bf16 v[76:79], v[136:139], v[48:51], v[76:79]
  s_waitcnt lgkmcnt(4)
  ds_read_b64_tr_b16 a[48:49], v22 offset:49152
  ds_read_b64_tr_b16 a[50:51], v22 offset:53248
  ds_read_b64_tr_b16 a[52:53], v23 offset:49152
  ds_read_b64_tr_b16 a[54:55], v23 offset:53248
  s_waitcnt lgkmcnt(8)
  ds_read_b64_tr_b16 a[56:57], v22 offset:57344
  ds_read_b64_tr_b16 a[58:59], v22 offset:61440
  ds_read_b64_tr_b16 a[60:61], v23 offset:57344
  ds_read_b64_tr_b16 a[62:63], v23 offset:61440
  v_mfma_f32_16x16x32_bf16 v[64:67], v[92:95], v[52:55], v[64:67]
  v_mfma_f32_16x16x32_bf16 v[68:71], v[108:111], v[52:55], v[68:71]
  v_mfma_f32_16x16x32_bf16 v[72:75], v[124:127], v[52:55], v[72:75]
  v_mfma_f32_16x16x32_bf16 v[76:79], v[140:143], v[52:55], v[76:79]
  s_nop 4
  v_max3_f32 v160, v64, v65, v66
  v_max3_f32 v160, v160, v67, v68
  v_max3_f32 v160, v160, v69, v70
  v_max3_f32 v160, v160, v71, v72
  v_max3_f32 v160, v160, v73, v74
  v_max3_f32 v160, v160, v75, v76
  v_max3_f32 v160, v160, v77, v78
  v_max_f32 v160, v160, v79
  v_mov_b32 v8, v160
  s_nop 1
  v_permlane16_swap_b32 v8, v160
  v_max_f32 v160, v160, v8
  v_mov_b32 v8, v160
  s_nop 1
  v_permlane32_swap_b32 v8, v160
  v_max_f32 v160, v160, v8
  v_sub_f32 v64, v64, v160
  v_sub_f32 v65, v65, v160
  v_sub_f32 v66, v66, v160
  v_sub_f32 v67, v67, v160
  v_sub_f32 v68, v68, v160
  v_sub_f32 v69, v69, v160
  v_sub_f32 v70, v70, v160
  v_sub_f32 v71, v71, v160
  v_sub_f32 v72, v72, v160
  v_sub_f32 v73, v73, v160
  v_sub_f32 v74, v74, v160
  v_sub_f32 v75, v75, v160
  v_sub_f32 v76, v76, v160
  v_sub_f32 v77, v77, v160
  v_sub_f32 v78, v78, v160
  v_sub_f32 v79, v79, v160
  v_exp_f32 v64, v64
  v_exp_f32 v65, v65
  v_exp_f32 v66, v66
  v_exp_f32 v67, v67
  v_exp_f32 v68, v68
  v_exp_f32 v69, v69
  v_exp_f32 v70, v70
  v_exp_f32 v71, v71
  v_exp_f32 v72, v72
  v_exp_f32 v73, v73
  v_exp_f32 v74, v74
  v_exp_f32 v75, v75
  v_exp_f32 v76, v76
  v_exp_f32 v77, v77
  v_exp_f32 v78, v78
  v_exp_f32 v79, v79
  v_cvt_pk_bf16_f32 v56, v64, v65
  v_cvt_pk_bf16_f32 v57, v66, v67
  v_cvt_pk_bf16_f32 v58, v68, v69
  v_cvt_pk_bf16_f32 v59, v70, v71
  v_cvt_pk_bf16_f32 v60, v72, v73
  v_cvt_pk_bf16_f32 v61, v74, v75
  v_cvt_pk_bf16_f32 v62, v76, v77
  v_cvt_pk_bf16_f32 v63, v78, v79
  ds_write_b64 v27, v[56:57] offset:0
  ds_write_b64 v27, v[58:59] offset:8
  ds_write_b64 v27, v[60:61] offset:256
  ds_write_b64 v27, v[62:63] offset:264
  v_pk_add_f32 v[64:65], v[64:65], v[72:73]
  v_pk_add_f32 v[66:67], v[66:67], v[74:75]
  v_pk_add_f32 v[68:69], v[68:69], v[76:77]
  v_pk_add_f32 v[70:71], v[70:71], v[78:79]
  v_pk_add_f32 v[64:65], v[64:65], v[68:69]
  v_pk_add_f32 v[66:67], v[66:67], v[70:71]
  v_pk_add_f32 v[64:65], v[64:65], v[66:67]
  v_add_f32 v161, v64, v65
  v_mov_b32 v8, v161
  s_nop 1
  v_permlane16_swap_b32 v8, v161
  v_add_f32 v161, v161, v8
  v_mov_b32 v8, v161
  s_nop 1
  v_permlane32_swap_b32 v8, v161
  v_add_f32 v161, v161, v8
  ds_write_b64 v30, v[160:161]
  s_waitcnt lgkmcnt(0)
  s_barrier
  ds_read_b128 v[144:147], v31
  ds_read_b128 v[148:151], v31 offset:16
  ds_read_b128 v[80:83], v28 offset:0
  ds_read_b128 v[84:87], v28 offset:256
  ds_read_b128 v[88:91], v28 offset:512
  ds_read_b128 v[92:95], v28 offset:768
  ds_read_b128 v[96:99], v28 offset:1024
  ds_read_b128 v[100:103], v28 offset:1280
  ds_read_b128 v[104:107], v28 offset:1536
  ds_read_b128 v[108:111], v28 offset:1792
  s_waitcnt lgkmcnt(7)
  v_mfma_f32_16x16x32_bf16 v[112:115], a[0:3], v[80:83], 0
  v_mfma_f32_16x16x32_bf16 v[116:119], a[4:7], v[80:83], 0
  v_max3_f32 v160, v144, v146, v148
  v_max_f32 v160, v160, v150
  v_sub_f32 v164, v144, v160
  v_sub_f32 v165, v146, v160
  v_sub_f32 v166, v148, v160
  v_sub_f32 v167, v150, v160
  s_waitcnt lgkmcnt(6)
  v_mfma_f32_16x16x32_bf16 v[112:115], a[8:11], v[84:87], v[112:115]
  v_mfma_f32_16x16x32_bf16 v[116:119], a[12:15], v[84:87], v[116:119]
  v_exp_f32 v164, v164
  v_exp_f32 v165, v165
  v_exp_f32 v166, v166
  v_exp_f32 v167, v167
  s_waitcnt lgkmcnt(5)
  v_mfma_f32_16x16x32_bf16 v[120:123], a[16:19], v[88:91], 0
  v_mfma_f32_16x16x32_bf16 v[124:127], a[20:23], v[88:91], 0
  v_mul_f32 v161, v164, v145
  v_fmac_f32 v161, v165, v147
  v_fmac_f32 v161, v166, v149
  v_fmac_f32 v161, v167, v151
  s_waitcnt lgkmcnt(4)
  v_mfma_f32_16x16x32_bf16 v[120:123], a[24:27], v[92:95], v[120:123]
  v_mfma_f32_16x16x32_bf16 v[124:127], a[28:31], v[92:95], v[124:127]
  v_mov_b32 v64, v160
  v_mov_b32 v65, v161
  v_mov_b32 v66, 0
  v_mov_b32 v67, 0
  v_perm_b32 v68, v64, v2, s57
  v_perm_b32 v69, v65, v2, s58
  v_perm_b32 v70, v66, v2, s59
  v_perm_b32 v71, v67, v2, s60
  s_waitcnt lgkmcnt(3)
  v_mfma_f32_16x16x32_bf16 v[128:131], a[32:35], v[96:99], 0
  v_mfma_f32_16x16x32_bf16 v[132:135], a[36:39], v[96:99], 0
  s_waitcnt lgkmcnt(2)
  v_mfma_f32_16x16x32_bf16 v[128:131], a[40:43], v[100:103], v[128:131]
  v_mfma_f32_16x16x32_bf16 v[132:135], a[44:47], v[100:103], v[132:135]
  s_waitcnt lgkmcnt(1)
  v_mfma_f32_16x16x32_bf16 v[136:139], a[48:51], v[104:107], 0
  v_mfma_f32_16x16x32_bf16 v[140:143], a[52:55], v[104:107], 0
  s_waitcnt lgkmcnt(0)
  v_mfma_f32_16x16x32_bf16 v[136:139], a[56:59], v[108:111], v[136:139]
  v_mfma_f32_16x16x32_bf16 v[140:143], a[60:63], v[108:111], v[140:143]
  v_pk_mul_f32 v[152:153], v[112:113], v[164:165] op_sel_hi:[1,0]
  v_pk_mul_f32 v[154:155], v[114:115], v[164:165] op_sel_hi:[1,0]
  v_pk_mul_f32 v[156:157], v[116:117], v[164:165] op_sel_hi:[1,0]
  v_pk_mul_f32 v[158:159], v[118:119], v[164:165] op_sel_hi:[1,0]
  v_pk_fma_f32 v[152:153], v[120:121], v[164:165], v[152:153] op_sel:[0,1,0] op_sel_hi:[1,1,1]
  v_pk_fma_f32 v[154:155], v[122:123], v[164:165], v[154:155] op_sel:[0,1,0] op_sel_hi:[1,1,1]
  v_pk_fma_f32 v[156:157], v[124:125], v[164:165], v[156:157] op_sel:[0,1,0] op_sel_hi:[1,1,1]
  v_pk_fma_f32 v[158:159], v[126:127], v[164:165], v[158:159] op_sel:[0,1,0] op_sel_hi:[1,1,1]
  v_pk_fma_f32 v[152:153], v[128:129], v[166:167], v[152:153] op_sel_hi:[1,0,1]
  v_pk_fma_f32 v[154:155], v[130:131], v[166:167], v[154:155] op_sel_hi:[1,0,1]
  v_pk_fma_f32 v[156:157], v[132:133], v[166:167], v[156:157] op_sel_hi:[1,0,1]
  v_pk_fma_f32 v[158:159], v[134:135], v[166:167], v[158:159] op_sel_hi:[1,0,1]
  v_pk_fma_f32 v[152:153], v[136:137], v[166:167], v[152:153] op_sel:[0,1,0] op_sel_hi:[1,1,1]
  v_pk_fma_f32 v[154:155], v[138:139], v[166:167], v[154:155] op_sel:[0,1,0] op_sel_hi:[1,1,1]
  v_pk_fma_f32 v[156:157], v[140:141], v[166:167], v[156:157] op_sel:[0,1,0] op_sel_hi:[1,1,1]
  v_pk_fma_f32 v[158:159], v[142:143], v[166:167], v[158:159] op_sel:[0,1,0] op_sel_hi:[1,1,1]
  v_perm_b32 v56, v152, v2, s57
  v_perm_b32 v57, v153, v2, s58
  v_perm_b32 v58, v154, v2, s59
  v_perm_b32 v59, v155, v2, s60
  v_perm_b32 v60, v156, v2, s57
  v_perm_b32 v61, v157, v2, s58
  v_perm_b32 v62, v158, v2, s59
  v_perm_b32 v63, v159, v2, s60
  s_mov_b64 exec, s[64:65]
  s_add_u32 s7, s73, 2097152
  buffer_store_dwordx4 v[56:59], v29, s[8:11], s7 offen
  s_add_u32 s7, s73, 2097152
  buffer_store_dwordx4 v[60:63], v29, s[8:11], s7 offen offset:64
  s_cmp_lg_u32 s3, 0
  s_cbranch_scc1 L_nost_55
  s_mov_b64 exec, 15
  s_add_u32 s7, s74, 2097152
  buffer_store_dwordx4 v[68:71], v32, s[8:11], s7 offen
  buffer_store_dwordx4 v[68:71], v32, s[8:11], s74 offen  sc1
  s_mov_b64 exec, s[64:65]
L_nost_55:
  buffer_store_dwordx4 v[56:59], v29, s[8:11], s73 offen  sc1
  buffer_store_dwordx4 v[60:63], v29, s[8:11], s73 offen offset:64 sc1
  s_mov_b64 exec, -1
  s_mov_b32 s12, s16
  s_mov_b32 s13, s17
  s_mov_b32 s14, 4096
  s_mov_b32 s15, 0x20000
  s_mov_b32 s44, s38
  s_mov_b32 s45, s39
  s_mov_b32 s46, 4096
  s_mov_b32 s47, 0x20000
  buffer_load_dwordx2 v[80:81], v168, s[12:15], 0 offen
  s_mov_b32 s75, 16384
  s_waitcnt vmcnt(0)
  v_lshlrev_b32 v180, 16, v80
  v_and_b32 v181, 0xffff0000, v80
  v_lshlrev_b32 v182, 16, v81
  v_and_b32 v183, 0xffff0000, v81
  s_mov_b32 s66, 0
L_poll_56:
  buffer_load_dwordx4 v[184:187], v176, s[8:11], s75 offen sc1
  s_waitcnt vmcnt(0)
  v_xor_b32 v184, s98, v184
  v_xor_b32 v185, s99, v185
  v_xor_b32 v186, s100, v186
  v_xor_b32 v187, s101, v187
  v_or3_b32 v8, v184, v185, v186
  v_or_b32 v8, v8, v187
  v_cmp_ne_u32_sdwa vcc, v8, v6 src0_sel:BYTE_0 src1_sel:DWORD
  s_cbranch_vccz L_ok_57
  s_add_u32 s66, s66, 1
  s_cmp_lt_u32 s66, 200000
  s_cbranch_scc1 L_poll_56
  s_branch L_exit
L_ok_57:
  s_lshl_b32 s75, s5, 14
  s_lshl_b32 s7, s3, 12
  s_add_u32 s75, s75, s7
  s_add_u32 s75, s75, 524288
  s_lshl_b32 s76, s4, 13
  s_add_u32 s76, s76, 786432
  s_mov_b32 s66, 0
  buffer_load_dwordx4 v[80:83], v170, s[8:11], s75 offen offset:0 sc1
  buffer_load_dwordx4 v[84:87], v170, s[8:11], s75 offen offset:1024 sc1
  buffer_load_dwordx4 v[88:91], v170, s[8:11], s75 offen offset:2048 sc1
  buffer_load_dwordx4 v[92:95], v170, s[8:11], s75 offen offset:3072 sc1
  s_waitcnt vmcnt(0)
  v_xor_b32 v80, s98, v80
  v_xor_b32 v81, s99, v81
  v_xor_b32 v82, s100, v82
  v_xor_b32 v83, s101, v83
  v_xor_b32 v84, s98, v84
  v_xor_b32 v85, s99, v85
  v_xor_b32 v86, s100, v86
  v_xor_b32 v87, s101, v87
  v_xor_b32 v88, s98, v88
  v_xor_b32 v89, s99, v89
  v_xor_b32 v90, s100, v90
  v_xor_b32 v91, s101, v91
  v_xor_b32 v92, s98, v92
  v_xor_b32 v93, s99, v93
  v_xor_b32 v94, s100, v94
  v_xor_b32 v95, s101, v95
  v_or3_b32 v8, v80, v81, v82
  v_or3_b32 v8, v8, v83, v84
  v_or3_b32 v8, v8, v85, v86
  v_or3_b32 v8, v8, v87, v88
  v_or3_b32 v8, v8, v89, v90
  v_or3_b32 v8, v8, v91, v92
  v_or3_b32 v8, v8, v93, v94
  v_or_b32 v8, v8, v95
  v_cmp_ne_u32_sdwa vcc, v8, v6 src0_sel:BYTE_0 src1_sel:DWORD
  s_cbranch_vccz L_ok_59
  s_mov_b32 s62, 15
L_poll_58:
  s_bitcmp1_b32 s62, 0
  s_cbranch_scc0 L_sk_60
  buffer_load_dwordx4 v[80:83], v170, s[8:11], s75 offen offset:0 sc1
L_sk_60:
  s_bitcmp1_b32 s62, 1
  s_cbranch_scc0 L_sk_61
  buffer_load_dwordx4 v[84:87], v170, s[8:11], s75 offen offset:1024 sc1
L_sk_61:
  s_bitcmp1_b32 s62, 2
  s_cbranch_scc0 L_sk_62
  buffer_load_dwordx4 v[88:91], v170, s[8:11], s75 offen offset:2048 sc1
L_sk_62:
  s_bitcmp1_b32 s62, 3
  s_cbranch_scc0 L_sk_63
  buffer_load_dwordx4 v[92:95], v170, s[8:11], s75 offen offset:3072 sc1
L_sk_63:
  s_waitcnt vmcnt(0)
  s_bitcmp1_b32 s62, 0
  s_cbranch_scc0 L_sk_64
  v_xor_b32 v80, s98, v80
  v_xor_b32 v81, s99, v81
  v_xor_b32 v82, s100, v82
  v_xor_b32 v83, s101, v83
  v_or3_b32 v8, v80, v81, v82
  v_or_b32 v8, v8, v83
  v_cmp_ne_u32_sdwa vcc, v8, v6 src0_sel:BYTE_0 src1_sel:DWORD
  s_cbranch_vccnz L_sk_64
  s_bitset0_b32 s62, 0
L_sk_64:
  s_bitcmp1_b32 s62, 1
  s_cbranch_scc0 L_sk_65
  v_xor_b32 v84, s98, v84
  v_xor_b32 v85, s99, v85
  v_xor_b32 v86, s100, v86
  v_xor_b32 v87, s101, v87
  v_or3_b32 v8, v84, v85, v86
  v_or_b32 v8, v8, v87
  v_cmp_ne_u32_sdwa vcc, v8, v6 src0_sel:BYTE_0 src1_sel:DWORD
  s_cbranch_vccnz L_sk_65
  s_bitset0_b32 s62, 1
L_sk_65:
  s_bitcmp1_b32 s62, 2
  s_cbranch_scc0 L_sk_66
  v_xor_b32 v88, s98, v88
  v_xor_b32 v89, s99, v89
  v_xor_b32 v90, s100, v90
  v_xor_b32 v91, s101, v91
  v_or3_b32 v8, v88, v89, v90
  v_or_b32 v8, v8, v91
  v_cmp_ne_u32_sdwa vcc, v8, v6 src0_sel:BYTE_0 src1_sel:DWORD
  s_cbranch_vccnz L_sk_66
  s_bitset0_b32 s62, 2
L_sk_66:
  s_bitcmp1_b32 s62, 3
  s_cbranch_scc0 L_sk_67
  v_xor_b32 v92, s98, v92
  v_xor_b32 v93, s99, v93
  v_xor_b32 v94, s100, v94
  v_xor_b32 v95, s101, v95
  v_or3_b32 v8, v92, v93, v94
  v_or_b32 v8, v8, v95
  v_cmp_ne_u32_sdwa vcc, v8, v6 src0_sel:BYTE_0 src1_sel:DWORD
  s_cbranch_vccnz L_sk_67
  s_bitset0_b32 s62, 3
L_sk_67:
  s_cmp_eq_u32 s62, 0
  s_cbranch_scc1 L_ok_59
  s_add_u32 s66, s66, 1
  s_cmp_lt_u32 s66, 200000
  s_cbranch_scc1 L_poll_58
  s_branch L_exit
L_ok_59:
  v_pk_add_f32 v[80:81], v[80:81], v[84:85]
  v_pk_add_f32 v[88:89], v[88:89], v[92:93]
  v_pk_add_f32 v[82:83], v[82:83], v[86:87]
  v_pk_add_f32 v[90:91], v[90:91], v[94:95]
  v_pk_add_f32 v[80:81], v[80:81], v[88:89]
  v_pk_add_f32 v[82:83], v[82:83], v[90:91]
  s_nop 0
  v_permlane16_swap_b32 v80, v81
  v_permlane16_swap_b32 v82, v83
  v_add_f32 v80, v80, v81
  v_add_f32 v82, v82, v83
  s_nop 1
  v_permlane32_swap_b32 v80, v82
  v_add_f32 v80, v80, v82
  ds_write_b32 v171, v80
  s_waitcnt lgkmcnt(0)
  s_barrier
  s_cmp_lg_u32 s3, 0
  s_cbranch_scc1 L_exit
  ds_read_b128 v[80:83], v172
  ds_read_b128 v[84:87], v172 offset:256
  s_waitcnt lgkmcnt(0)
  v_pk_add_f32 v[80:81], v[80:81], v[84:85]
  v_pk_add_f32 v[82:83], v[82:83], v[86:87]
  v_pk_fma_f32 v[192:193], v[184:185], v[80:81], v[180:181]
  v_pk_fma_f32 v[194:195], v[186:187], v[82:83], v[182:183]
  v_perm_b32 v80, v192, v2, s57
  v_perm_b32 v81, v193, v2, s58
  v_perm_b32 v82, v194, v2, s59
  v_perm_b32 v83, v195, v2, s60
  s_mov_b32 exec_hi, 0
  s_add_u32 s7, s76, 2097152
  buffer_store_dwordx4 v[80:83], v169, s[8:11], s7 offen
  buffer_store_dwordx4 v[80:83], v169, s[8:11], s76 offen  sc1
  ds_write_b128 v173, v[192:195]
  s_mov_b64 exec, -1
  v_and_b32 v9, 3, v1
  v_lshlrev_b32 v9, 4, v9
  s_lshl_b32 s75, s5, 3
  s_add_u32 s75, s75, s4
  s_lshr_b32 s76, s75, 1
  s_mul_i32 s76, s76, 3584
  s_and_b32 s7, s75, 1
  s_lshl_b32 s7, s7, 6
  s_add_u32 s76, s76, s7
  s_add_u32 s76, s76, 851968
  s_lshl_b32 s75, s75, 6
  s_add_u32 s75, s75, 40960
  s_mov_b32 s66, 0
L_poll_68:
  buffer_load_dwordx4 v[188:191], v9, s[8:11], s75 offen sc1
  s_waitcnt vmcnt(0)
  v_xor_b32 v188, s98, v188
  v_xor_b32 v189, s99, v189
  v_xor_b32 v190, s100, v190
  v_xor_b32 v191, s101, v191
  v_or3_b32 v8, v188, v189, v190
  v_or_b32 v8, v8, v191
  v_cmp_ne_u32_sdwa vcc, v8, v6 src0_sel:BYTE_0 src1_sel:DWORD
  s_cbranch_vccz L_ok_69
  s_add_u32 s66, s66, 1
  s_cmp_lt_u32 s66, 200000
  s_cbranch_scc1 L_poll_68
  s_branch L_exit
L_ok_69:
  v_lshrrev_b32 v9, 4, v1
  v_cmp_eq_u32 vcc, 1, v9
  s_nop 1
  v_cndmask_b32 v188, v188, v189, vcc
  v_cmp_eq_u32 vcc, 2, v9
  s_nop 1
  v_cndmask_b32 v188, v188, v190, vcc
  v_cmp_eq_u32 vcc, 3, v9
  s_nop 1
  v_cndmask_b32 v188, v188, v191, vcc
  ds_read_b32 v192, v174
  v_mov_b32 v84, 0
  v_mov_b32 v85, 0
  v_mov_b32 v86, 0
  v_mov_b32 v87, 0
  s_mov_b32 s78, -1
  s_mov_b32 s79, 65535
  s_mov_b32 s66, 0
L_poll_70:
  buffer_load_dwordx4 v[80:83], v177, s[8:11], s76 offen sc1
  s_mov_b64 exec, s[78:79]
  buffer_load_dwordx4 v[84:87], v177, s[8:11], s76 offen offset:2048 sc1
  s_mov_b64 exec, -1
  s_waitcnt vmcnt(0)
  v_xor_b32 v80, s98, v80
  v_xor_b32 v81, s99, v81
  v_xor_b32 v82, s100, v82
  v_xor_b32 v83, s101, v83
  v_or3_b32 v8, v80, v81, v82
  v_or_b32 v8, v8, v83
  v_cmp_ne_u32_sdwa vcc, v8, v6 src0_sel:BYTE_0 src1_sel:DWORD
  s_mov_b64 s[62:63], vcc
  s_mov_b64 exec, s[78:79]
  v_xor_b32 v84, s98, v84
  v_xor_b32 v85, s99, v85
  v_xor_b32 v86, s100, v86
  v_xor_b32 v87, s101, v87
  v_or3_b32 v8, v84, v85, v86
  v_or_b32 v8, v8, v87
  v_cmp_ne_u32_sdwa vcc, v8, v6 src0_sel:BYTE_0 src1_sel:DWORD
  s_mov_b64 exec, -1
  s_or_b64 s[62:63], vcc, s[62:63]
  s_cbranch_scc0 L_ok_71
  s_add_u32 s66, s66, 1
  s_cmp_lt_u32 s66, 200000
  s_cbranch_scc1 L_poll_70
  s_branch L_exit
L_ok_71:
  v_pk_add_f32 v[80:81], v[80:81], v[84:85]
  v_pk_add_f32 v[82:83], v[82:83], v[86:87]
  s_nop 0
  v_add_f32_dpp v80, v80, v80 row_ror:4 row_mask:0xf bank_mask:0xf
  v_add_f32_dpp v81, v81, v81 row_ror:4 row_mask:0xf bank_mask:0xf
  v_add_f32_dpp v82, v82, v82 row_ror:4 row_mask:0xf bank_mask:0xf
  v_add_f32_dpp v83, v83, v83 row_ror:4 row_mask:0xf bank_mask:0xf
  v_add_f32_dpp v80, v80, v80 row_ror:8 row_mask:0xf bank_mask:0xf
  v_add_f32_dpp v81, v81, v81 row_ror:8 row_mask:0xf bank_mask:0xf
  v_add_f32_dpp v82, v82, v82 row_ror:8 row_mask:0xf bank_mask:0xf
  v_add_f32_dpp v83, v83, v83 row_ror:8 row_mask:0xf bank_mask:0xf
  v_permlane16_swap_b32 v80, v81
  s_nop 0
  v_permlane16_swap_b32 v82, v83
  v_add_f32 v80, v80, v81
  v_add_f32 v82, v82, v83
  s_nop 1
  v_permlane32_swap_b32 v80, v82
  v_add_f32 v80, v80, v82
  s_waitcnt lgkmcnt(0)
  v_fma_f32 v192, v188, v80, v192
  v_cvt_pk_bf16_f32 v80, v192, v192
  s_mov_b64 exec, s[64:65]
  buffer_store_short v80, v175, s[44:47], 0 offen
  s_mov_b64 exec, -1
  s_branch L_exit
L_exit:
L_end:
  s_endpgm
.section .rodata,"a"
.p2align 6
.amdhsa_kernel adaLN_cond__sliding_block_cached__glu_gated_glu__decode_kernel
  .amdhsa_next_free_vgpr 400
  .amdhsa_next_free_sgpr 102
  .amdhsa_accum_offset 204
  .amdhsa_group_segment_fixed_size 0
  .amdhsa_kernarg_size 112
  .amdhsa_user_sgpr_count 2
  .amdhsa_user_sgpr_kernarg_segment_ptr 1
  .amdhsa_system_sgpr_workgroup_id_x 1
  .amdhsa_float_denorm_mode_32 3
.end_amdhsa_kernel
```
